```python
import torch

def _softmax(x, axis=-1):
    return torch.softmax(x, dim=axis)

def _gelu(x):
    return torch.nn.functional.gelu(x, approximate='tanh')

def _silu(x):
    return torch.nn.functional.silu(x)

def _sigmoid(x):
    return torch.sigmoid(x)

def _layernorm(x, axis=-1, eps=1e-05):
    m = x.mean(dim=axis, keepdim=True)
    v = x.var(dim=axis, keepdim=True, unbiased=False)
    return (x - m) / torch.sqrt(v + eps)

def _scatter_add(tgt, idx, src, axis=0):
    return tgt.clone().index_add_(axis, idx, src)

def _segment_sum(src, seg, n):
    out = torch.zeros((n,) + src.shape[1:], dtype=src.dtype)
    return out.index_add_(0, seg, src)

def _pad(x, pw):
    flat = tuple((v for pair in reversed(pw) for v in pair))
    return torch.nn.functional.pad(x, flat)
kernel_name = 'standalone__conformer_conv_module__speech'

def setup_inputs():

    _w = lambda a: (lambda t: t.to(torch.bfloat16) if t.is_floating_point() else t)(torch.as_tensor(a))
    B, T, D, K = (2, 16000, 256, 31)
    return {'x': _w((lambda *s: torch.randn(*s, dtype=torch.bfloat16) * 0.2)(B, T, D)), 'w_pw1': _w((lambda *s: torch.randn(*s, dtype=torch.bfloat16) * 0.2)(D, 2 * D)), 'dw': _w((lambda *s: torch.randn(*s, dtype=torch.bfloat16) * 0.2)(K, D)), 'w_pw2': _w((lambda *s: torch.randn(*s, dtype=torch.bfloat16) * 0.05)(D, D))}

def reference(x, w_pw1, dw, w_pw2):
    B, T, D = x.shape
    K = dw.shape[0]
    h = x @ w_pw1
    a, b = (h[..., :D].clone(), h[..., D:].clone())
    h = a * _sigmoid(b)
    pad = K // 2
    hp = _pad(h, ((0, 0), (pad, pad), (0, 0)))
    out = torch.zeros_like(h)
    for i in range(K):
        out = out + hp[:, i:i + T, :] * dw[i][None, None, :]
    return _silu(out) @ w_pw2
```

```asm
; @launch grid=(250,1,1) block=(512,1,1) lds=163840
.amdgcn_target "amdgcn-amd-amdhsa--gfx950"
.text
.globl standalone__conformer_conv_module__speech_kernel
.p2align 12
L_sec0:
.p2align 8
.type standalone__conformer_conv_module__speech_kernel,@function
standalone__conformer_conv_module__speech_kernel:
    s_setprio 3
    s_load_dwordx8 s[36:43], s[0:1], 0
    s_load_dwordx2 s[44:45], s[0:1], 32
    s_load_dwordx2 s[4:5], s[0:1], 48
    s_cmp_ge_u32 s2, 250
    s_cbranch_scc1 L_end
    s_getpc_b64 s[34:35]
    L_pc:
    s_bfe_u32 s46, s2, 327683
    s_lshl_b32 s46, s46, 10
    v_lshrrev_b32 v38, 6, v0
    v_lshlrev_b32 v38, 7, v38
    v_add_u32 v38, s46, v38
    v_min_u32 v38, L_end-L_pc, v38
    v_mov_b32 v39, s35
    v_add_co_u32 v38, vcc, s34, v38
    v_lshrrev_b32 v28, 6, v0
    v_and_b32 v0, 63, v0
    v_addc_co_u32 v39, vcc, 0, v39, vcc
    global_load_dword v247, v[38:39], off
    v_readfirstlane_b32 s28, v28
    s_and_b32 s46, s2, 7
    s_lshr_b32 s47, s2, 3
    s_mul_i32 s48, s46, 31
    s_min_u32 s46, s46, 2
    s_add_u32 s48, s48, s46
    s_add_u32 s48, s48, s47
    s_and_b32 s49, s47, 15
    s_lshl_b32 s64, s49, 14
    s_lshl_b32 s52, s48, 16
    s_mul_i32 s29, s28, 10240
    s_lshl_b32 s50, s28, 6
    v_lshrrev_b32 v34, 5, v0
    v_lshrrev_b32 v35, 2, v0
    v_and_b32 v36, 3, v0
    v_lshlrev_b32 v32, 4, v36
    v_add_u32 v32, s50, v32
    v_lshl_add_u32 v4, v35, 10, v32
    v_and_b32 v30, 32, v0
    v_xor_b32 v4, v4, v30
    v_lshlrev_b32 v10, 9, v34
    v_lshl_add_u32 v5, v35, 9, v32
    s_lshl_b32 s49, s49, 1
    v_add_u32 v29, s49, v0
    v_and_b32 v29, 31, v29
    v_lshlrev_b32 v29, 1, v29
    v_add_lshl_u32 v3, v29, v10, 3
    s_and_b32 s60, s28, 3
    s_mul_i32 s60, s60, 0x1400
    s_and_b32 s60, s60, 0x2400
    s_lshr_b32 s61, s28, 2
    s_lshl_b32 s61, s61, 11
    s_or_b32 s60, s60, s61
    s_mul_i32 s31, s28, 2112
    v_add_u32 v28, 8192, v5
    s_mov_b32 s10, 65536
    s_mov_b32 s11, 0x20000
    s_mov_b32 s18, 15872
    s_mov_b32 s19, 0x20000
    s_add_u32 m0, s29, 7936
    s_waitcnt lgkmcnt(0)
    s_mov_b32 s16, s40
    s_mov_b32 s17, s41
    buffer_load_dwordx4 v5, s[16:19], 0 offen lds
    s_add_u32 m0, s29, 8960
    s_add_u32 s8, s36, s52
    s_addc_u32 s9, s37, 0
    buffer_load_dwordx4 v28, s[16:19], 0 offen lds
    s_add_u32 m0, s31, 81920
    s_mov_b32 s12, s38
    buffer_load_dwordx4 v3, s[8:11], s60 offen nt lds
    s_add_u32 m0, s31, 82464
    s_mov_b32 s13, s39
    buffer_load_dwordx4 v3, s[8:11], s60 offen offset:512 nt lds
    s_add_u32 m0, s31, 98816
    s_add_u32 s60, s60, 16384
    buffer_load_dwordx4 v3, s[8:11], s60 offen nt lds
    s_add_u32 m0, s31, 99360
    s_mov_b32 s14, 262144
    buffer_load_dwordx4 v3, s[8:11], s60 offen offset:512 nt lds
    s_mov_b32 s15, 0x20000
    s_setprio 0
    s_lshl_b32 s62, s47, 2
    s_add_u32 s62, s62, s28
    s_lshl_b32 s62, s62, 10
    s_mul_i32 s61, s28, 5760
    s_add_u32 s61, s61, 115712
    s_cmp_ge_u32 s28, 4
    s_cselect_b32 s61, s29, s61
    v_and_b32 v43, 3, v35
    v_add_u32 v43, v43, v34
    v_lshl_add_u32 v43, v43, 6, s29
    v_and_b32 v44, 16, v0
    v_lshl_add_u32 v43, v44, 1, v43
    v_lshl_add_u32 v40, v36, 3, v43
    v_and_b32 v43, 31, v0
    v_mul_u32_u24 v43, 88, v43
    v_mul_u32_u24 v44, 2880, v34
    v_add3_u32 v41, v43, v44, s61
    v_mul_u32_u24 v43, 88, v35
    v_xor_b32 v44, 3, v36
    v_and_b32 v42, 2, v44
    v_lshl_add_u32 v43, v42, 1, v43
    v_and_b32 v44, 1, v44
    v_mul_u32_u24 v44, 2880, v44
    v_add3_u32 v42, v43, v44, s61
    v_add_u32 v43, 1408, v42
    v_lshl_add_u32 v56, v0, 2, s29
    v_mov_b32 v57, 0
    ds_write_b32 v56, v57 offset:7680
    ds_write_b32 v56, v57 offset:9984
    s_mov_b32 s20, s42
    s_mov_b32 s21, s43
    s_mov_b32 s22, 131072
    s_mov_b32 s23, 0x20000
    s_mov_b32 s24, s44
    s_mov_b32 s25, s45
    s_mov_b32 s26, 16384000
    s_add_u32 s33, s48, 1
    s_cmp_eq_u32 s48, 124
    s_cselect_b32 s33, 0, s33
    s_cmp_eq_u32 s48, 249
    s_cselect_b32 s33, 125, s33
    s_lshl_b32 s63, s33, 16
    s_lshl_b32 s33, s33, 3
    s_add_u32 s33, s33, s28
    s_lshl_b32 s33, s33, 9
    s_lshl_b32 s32, s48, 3
    s_add_u32 s32, s32, s28
    s_lshl_b32 s32, s32, 9
    s_mov_b32 s27, 0x20000
    s_mov_b32 s6, 0x800000
    s_mov_b32 s7, 0x20000
    v_mbcnt_lo_u32_b32 v48, -1, 0
    v_mbcnt_hi_u32_b32 v48, -1, v48
    v_lshrrev_b32 v49, 2, v48
    v_and_b32 v50, 3, v48
    v_and_b32 v51, 3, v49
    v_and_b32 v52, 48, v48
    v_lshlrev_b32 v52, 5, v52
    v_lshl_add_u32 v51, v51, 6, v52
    v_and_b32 v52, 16, v48
    v_lshl_add_u32 v53, v52, 1, v51
    v_lshl_add_u32 v53, v50, 3, v53
    v_add_u32 v85, 81920, v53
    v_xor_b32 v86, 32, v85
    v_lshl_add_u32 v51, v50, 4, v51
    s_and_b32 s30, s28, 3
    s_lshl_b32 s30, s30, 12
    s_add_u32 s30, s30, 98816
    s_lshr_b32 s55, s28, 2
    s_mul_i32 s54, s55, 16896
    s_add_u32 s30, s30, s54
    v_add_u32 v81, s29, v51
    v_add_u32 v84, s30, v51
    v_lshl_add_u32 v51, v49, 4, s29
    v_lshlrev_b32 v54, 6, v50
    v_add_u32 v52, 0, v54
    v_and_b32 v53, 0xc0, v52
    v_xor_b32 v53, v51, v53
    v_lshl_add_u32 v76, v52, 3, v53
    v_add_u32 v52, 64, v54
    v_and_b32 v53, 0xc0, v52
    v_xor_b32 v53, v51, v53
    v_lshl_add_u32 v77, v52, 3, v53
    v_add_u32 v52, 128, v54
    v_and_b32 v53, 0xc0, v52
    v_xor_b32 v53, v51, v53
    v_lshl_add_u32 v78, v52, 3, v53
    v_add_u32 v52, 192, v54
    v_and_b32 v53, 0xc0, v52
    v_xor_b32 v53, v51, v53
    v_lshl_add_u32 v79, v52, 3, v53
    s_lshl_b32 s54, s28, 11
    s_add_u32 s54, s54, 81920
    v_lshl_add_u32 v54, v48, 4, s54
    v_and_b32 v53, 32, v48
    v_xor_b32 v80, v54, v53
    v_lshlrev_b32 v52, 3, v48
    v_xor_b32 v52, v52, v48
    v_and_b32 v53, 15, v48
    v_lshl_add_u32 v53, v53, 6, s54
    v_and_or_b32 v82, v52, 48, v53
    v_lshlrev_b32 v52, 1, v48
    v_and_b32 v52, 48, v52
    v_xor_b32 v83, v52, v54
    s_mul_i32 s54, s28, 3072
    s_add_u32 s54, s54, 138752
    s_mov_b32 s3, s54
    v_lshl_add_u32 v12, v48, 4, s54
    ds_write_b128 v12, v[76:79]
    ds_write_b128 v12, v[80:83] offset:1024
    ds_write_b128 v12, v[84:87] offset:2048
    s_mov_b32 s36, 0
    s_mov_b32 s37, 7168
    s_mov_b32 s38, 16384
    s_mov_b32 s39, 23552
    s_mov_b32 s40, 32768
    s_mov_b32 s41, 39936
    s_mov_b32 s42, 47104
    s_mov_b32 s43, 54272
    s_mov_b32 s44, 65536
    s_mov_b32 s45, 72704
    s_mov_b32 s46, 81920
    s_mov_b32 s47, 89088
    s_mov_b32 s48, 98304
    s_mov_b32 s49, 105472
    s_mov_b32 s50, 112640
    s_mov_b32 s51, 119808
    v_bfe_u32 v28, v0, 3, 1
    v_lshl_add_u32 v28, v28, 2, v36
    v_mul_u32_u24 v28, 1056, v28
    v_bfe_u32 v29, v0, 2, 1
    v_lshl_add_u32 v28, v29, 9, v28
    v_and_b32 v29, 48, v0
    v_add_u32 v28, v28, v29
    v_add_u32 v1, 81920, v28
    v_and_b32 v30, 3, v35
    v_lshl_add_u32 v31, v29, 5, s29
    v_lshl_add_u32 v28, v30, 6, v31
    v_and_b32 v30, 16, v0
    v_lshl_add_u32 v28, v30, 1, v28
    v_lshl_add_u32 v2, v36, 3, v28
    v_xor_b32 v7, 32, v2
    v_lshrrev_b32 v28, 2, v29
    v_and_b32 v30, 15, v0
    v_xor_b32 v28, v28, v30
    v_lshl_add_u32 v6, v28, 4, v31
    v_lshlrev_b32 v11, 4, v0
    v_mov_b32 v8, 0xbfb8aa3b
    v_mov_b32 v9, 0xbf317218
    s_waitcnt vmcnt(4)
    ds_read_b64_tr_b16 v[56:57], v40 offset:7680
    ds_read_b64_tr_b16 v[58:59], v40 offset:7936
    ds_read_b64_tr_b16 v[60:61], v40 offset:8192
    ds_read_b64_tr_b16 v[62:63], v40 offset:8448
    ds_read_b64_tr_b16 v[64:65], v40 offset:8704
    ds_read_b64_tr_b16 v[66:67], v40 offset:8960
    ds_read_b64_tr_b16 v[68:69], v40 offset:9216
    ds_read_b64_tr_b16 v[70:71], v40 offset:9472
    ds_read_b64_tr_b16 v[72:73], v40 offset:9728
    ds_read_b64_tr_b16 v[74:75], v40 offset:9984
    s_cmp_ge_u32 s28, 4
    s_cbranch_scc1 L_nolv
    s_add_u32 s65, s64, 16384
    s_and_b32 s65, s65, 0x3ffff
    s_add_u32 m0, s29, 0
    s_nop 0
    buffer_load_dwordx4 v4, s[12:15], s64 offen lds
    s_add_u32 m0, s29, 1536
    s_nop 0
    buffer_load_dwordx4 v4, s[12:15], s64 offen offset:512 lds
    s_add_u32 m0, s29, 1024
    s_nop 0
    buffer_load_dwordx4 v4, s[12:15], s65 offen lds
    s_add_u32 m0, s29, 2560
    s_nop 0
    buffer_load_dwordx4 v4, s[12:15], s65 offen offset:512 lds
    s_lshl_b32 s54, s62, 1
    v_lshlrev_b32 v31, 4, v0
    v_and_b32 v30, 0x300, v31
    v_add_u32 v30, v30, v31
    buffer_load_dwordx4 v[248:251], v30, s[12:15], s54 offen offset:256
    L_nolv:
    s_waitcnt lgkmcnt(9)
    ds_write_b64 v41, v[56:57]
    s_waitcnt lgkmcnt(9)
    ds_write_b64 v41, v[58:59] offset:8
    s_waitcnt lgkmcnt(9)
    ds_write_b64 v41, v[60:61] offset:16
    s_waitcnt lgkmcnt(9)
    ds_write_b64 v41, v[62:63] offset:24
    s_waitcnt lgkmcnt(9)
    ds_write_b64 v41, v[64:65] offset:32
    s_waitcnt lgkmcnt(9)
    ds_write_b64 v41, v[66:67] offset:40
    s_waitcnt lgkmcnt(9)
    ds_write_b64 v41, v[68:69] offset:48
    s_waitcnt lgkmcnt(9)
    ds_write_b64 v41, v[70:71] offset:56
    s_waitcnt lgkmcnt(9)
    ds_write_b64 v41, v[72:73] offset:64
    s_waitcnt lgkmcnt(9)
    ds_write_b64 v41, v[74:75] offset:72
    ds_read2_b32 v[92:93], v42 offset0:0 offset1:1
    ds_read2_b32 v[94:95], v42 offset0:2 offset1:3
    ds_read2_b32 v[96:97], v42 offset0:4 offset1:5
    ds_read2_b32 v[98:99], v42 offset0:6 offset1:7
    ds_read2_b32 v[100:101], v42 offset0:8 offset1:9
    ds_read2_b32 v[102:103], v42 offset0:10 offset1:11
    ds_read2_b32 v[104:105], v42 offset0:12 offset1:13
    ds_read2_b32 v[106:107], v42 offset0:14 offset1:15
    ds_read2_b32 v[108:109], v42 offset0:16 offset1:17
    ds_read2_b32 v[110:111], v43 offset0:0 offset1:1
    ds_read2_b32 v[112:113], v43 offset0:2 offset1:3
    ds_read2_b32 v[114:115], v43 offset0:4 offset1:5
    ds_read2_b32 v[116:117], v43 offset0:6 offset1:7
    ds_read2_b32 v[118:119], v43 offset0:8 offset1:9
    ds_read2_b32 v[120:121], v43 offset0:10 offset1:11
    ds_read2_b32 v[122:123], v43 offset0:12 offset1:13
    ds_read2_b32 v[124:125], v43 offset0:14 offset1:15
    ds_read2_b32 v[126:127], v43 offset0:16 offset1:17
    s_cmp_ge_u32 s28, 4
    s_cbranch_scc0 L_lead
    s_waitcnt vmcnt(0)
    s_barrier
    s_branch L_trail
    .fill (2652 - (. - L_sec0)) / 4, 4, 0xbf800000
    L_lead:
    s_add_u32 s66, s65, 16384
    s_and_b32 s66, s66, 0x3ffff
    s_add_u32 s67, s66, 16384
    s_and_b32 s67, s67, 0x3ffff
    s_add_u32 s68, s67, 16384
    s_and_b32 s68, s68, 0x3ffff
    s_add_u32 s69, s68, 16384
    s_and_b32 s69, s69, 0x3ffff
    s_add_u32 s70, s69, 16384
    s_and_b32 s70, s70, 0x3ffff
    s_add_u32 s71, s70, 16384
    s_and_b32 s71, s71, 0x3ffff
    s_add_u32 s72, s71, 16384
    s_and_b32 s72, s72, 0x3ffff
    s_add_u32 s73, s72, 16384
    s_and_b32 s73, s73, 0x3ffff
    s_add_u32 s74, s73, 16384
    s_and_b32 s74, s74, 0x3ffff
    s_add_u32 s75, s74, 16384
    s_and_b32 s75, s75, 0x3ffff
    s_add_u32 s76, s75, 16384
    s_and_b32 s76, s76, 0x3ffff
    s_add_u32 s77, s76, 16384
    s_and_b32 s77, s77, 0x3ffff
    s_add_u32 s78, s77, 16384
    s_and_b32 s78, s78, 0x3ffff
    s_add_u32 s79, s78, 16384
    s_and_b32 s79, s79, 0x3ffff
    s_add_u32 m0, s29, 4096
    s_nop 0
    buffer_load_dwordx4 v4, s[12:15], s66 offen lds
    s_add_u32 m0, s29, 5120
    s_nop 0
    buffer_load_dwordx4 v4, s[12:15], s67 offen lds
    s_add_u32 m0, s29, 5632
    s_nop 0
    buffer_load_dwordx4 v4, s[12:15], s66 offen offset:512 lds
    s_add_u32 m0, s29, 6656
    s_nop 0
    buffer_load_dwordx4 v4, s[12:15], s67 offen offset:512 lds
    s_add_u32 m0, s29, 8192
    s_nop 0
    buffer_load_dwordx4 v4, s[12:15], s68 offen lds
    s_add_u32 m0, s29, 9216
    s_nop 0
    buffer_load_dwordx4 v4, s[12:15], s69 offen lds
    s_waitcnt vmcnt(11)
    s_barrier
    ds_read_b128 v[16:19], v1
    ds_read_b128 v[20:23], v1 offset:8448
    s_waitcnt vmcnt(8)
    ds_read_b64_tr_b16 v[128:129], v2
    ds_read_b64_tr_b16 v[130:131], v2 offset:256
    ds_read_b64_tr_b16 v[132:133], v7
    ds_read_b64_tr_b16 v[134:135], v7 offset:256
    s_waitcnt vmcnt(7)
    ds_read_b64_tr_b16 v[136:137], v2 offset:2048
    ds_read_b64_tr_b16 v[138:139], v2 offset:2304
    ds_read_b64_tr_b16 v[140:141], v7 offset:2048
    ds_read_b64_tr_b16 v[142:143], v7 offset:2304
    s_mov_b32 m0, s29
    s_add_u32 s54, s68, 512
    s_waitcnt lgkmcnt(4)
    buffer_load_dwordx4 v4, s[12:15], s54 offen lds
    s_add_u32 m0, s29, 512
    s_nop 0
    buffer_load_dwordx4 v4, s[12:15], s69 offen offset:512 lds
    v_mfma_f32_16x16x32_bf16 v[28:31], v[16:19], v[128:131], 0
    ds_read_b128 v[24:27], v1 offset:16896
    v_mfma_f32_16x16x32_bf16 v[36:39], v[16:19], v[132:135], 0
    s_waitcnt vmcnt(6) lgkmcnt(1)
    ds_read_b64_tr_b16 v[144:145], v2 offset:4096
    v_mfma_f32_16x16x32_bf16 v[44:47], v[16:19], v[136:139], 0
    ds_read_b64_tr_b16 v[146:147], v2 offset:4352
    s_add_u32 m0, s29, 2048
    v_mfma_f32_16x16x32_bf16 v[52:55], v[16:19], v[140:143], 0
    buffer_load_dwordx4 v4, s[12:15], s70 offen lds
    v_mfma_f32_16x16x32_bf16 v[32:35], v[20:23], v[128:131], 0
    ds_read_b128 v[16:19], v1 offset:25344
    v_mfma_f32_16x16x32_bf16 v[40:43], v[20:23], v[132:135], 0
    ds_read_b64_tr_b16 v[148:149], v7 offset:4096
    v_mfma_f32_16x16x32_bf16 v[48:51], v[20:23], v[136:139], 0
    ds_read_b64_tr_b16 v[150:151], v7 offset:4352
    s_add_u32 m0, s29, 3072
    v_mfma_f32_16x16x32_bf16 v[56:59], v[20:23], v[140:143], 0
    s_waitcnt lgkmcnt(5)
    buffer_load_dwordx4 v4, s[12:15], s71 offen lds
    v_mfma_f32_16x16x32_bf16 v[60:63], v[24:27], v[128:131], 0
    ds_read_b128 v[20:23], v1 offset:64
    v_mfma_f32_16x16x32_bf16 v[68:71], v[24:27], v[132:135], 0
    s_waitcnt vmcnt(6)
    ds_read_b64_tr_b16 v[152:153], v2 offset:6144
    v_mfma_f32_16x16x32_bf16 v[76:79], v[24:27], v[136:139], 0
    ds_read_b64_tr_b16 v[154:155], v2 offset:6400
    s_add_u32 m0, s29, 3584
    v_mfma_f32_16x16x32_bf16 v[84:87], v[24:27], v[140:143], 0
    s_waitcnt lgkmcnt(5)
    s_waitcnt lgkmcnt(3)
    buffer_load_dwordx4 v4, s[12:15], s70 offen offset:512 lds
    v_mfma_f32_16x16x32_bf16 v[64:67], v[16:19], v[128:131], 0
    ds_read_b128 v[24:27], v1 offset:8512
    ds_read_b64_tr_b16 v[156:157], v7 offset:6144
    v_mfma_f32_16x16x32_bf16 v[72:75], v[16:19], v[132:135], 0
    ds_read_b64_tr_b16 v[158:159], v7 offset:6400
    v_mfma_f32_16x16x32_bf16 v[80:83], v[16:19], v[136:139], 0
    s_add_u32 m0, s29, 4608
    v_mfma_f32_16x16x32_bf16 v[88:91], v[16:19], v[140:143], 0
    s_waitcnt lgkmcnt(5)
    buffer_load_dwordx4 v4, s[12:15], s71 offen offset:512 lds
    v_mfma_f32_16x16x32_bf16 v[28:31], v[20:23], v[144:147], v[28:31]
    ds_read_b128 v[16:19], v1 offset:16960
    v_mfma_f32_16x16x32_bf16 v[36:39], v[20:23], v[148:151], v[36:39]
    s_waitcnt vmcnt(6) lgkmcnt(1)
    ds_read_b64_tr_b16 v[160:161], v2 offset:8192
    v_mfma_f32_16x16x32_bf16 v[44:47], v[20:23], v[152:155], v[44:47]
    ds_read_b64_tr_b16 v[162:163], v2 offset:8448
    s_add_u32 m0, s29, 6144
    v_mfma_f32_16x16x32_bf16 v[52:55], v[20:23], v[156:159], v[52:55]
    buffer_load_dwordx4 v4, s[12:15], s72 offen lds
    v_mfma_f32_16x16x32_bf16 v[32:35], v[24:27], v[144:147], v[32:35]
    ds_read_b128 v[20:23], v1 offset:25408
    v_mfma_f32_16x16x32_bf16 v[40:43], v[24:27], v[148:151], v[40:43]
    ds_read_b64_tr_b16 v[164:165], v7 offset:8192
    v_mfma_f32_16x16x32_bf16 v[48:51], v[24:27], v[152:155], v[48:51]
    ds_read_b64_tr_b16 v[166:167], v7 offset:8448
    s_add_u32 m0, s29, 7168
    v_mfma_f32_16x16x32_bf16 v[56:59], v[24:27], v[156:159], v[56:59]
    s_waitcnt lgkmcnt(5)
    buffer_load_dwordx4 v4, s[12:15], s73 offen lds
    v_mfma_f32_16x16x32_bf16 v[60:63], v[16:19], v[144:147], v[60:63]
    ds_read_b128 v[24:27], v1 offset:128
    v_mfma_f32_16x16x32_bf16 v[68:71], v[16:19], v[148:151], v[68:71]
    s_waitcnt vmcnt(6)
    ds_read_b64_tr_b16 v[168:169], v2
    v_mfma_f32_16x16x32_bf16 v[76:79], v[16:19], v[152:155], v[76:79]
    ds_read_b64_tr_b16 v[170:171], v2 offset:256
    s_add_u32 m0, s29, 7680
    v_mfma_f32_16x16x32_bf16 v[84:87], v[16:19], v[156:159], v[84:87]
    s_waitcnt lgkmcnt(5)
    s_waitcnt lgkmcnt(3)
    buffer_load_dwordx4 v4, s[12:15], s72 offen offset:512 lds
    v_mfma_f32_16x16x32_bf16 v[64:67], v[20:23], v[144:147], v[64:67]
    ds_read_b128 v[16:19], v1 offset:8576
    ds_read_b64_tr_b16 v[172:173], v7
    v_mfma_f32_16x16x32_bf16 v[72:75], v[20:23], v[148:151], v[72:75]
    ds_read_b64_tr_b16 v[174:175], v7 offset:256
    v_mfma_f32_16x16x32_bf16 v[80:83], v[20:23], v[152:155], v[80:83]
    s_add_u32 m0, s29, 8704
    v_mfma_f32_16x16x32_bf16 v[88:91], v[20:23], v[156:159], v[88:91]
    s_waitcnt lgkmcnt(5)
    buffer_load_dwordx4 v4, s[12:15], s73 offen offset:512 lds
    v_mfma_f32_16x16x32_bf16 v[28:31], v[24:27], v[160:163], v[28:31]
    ds_read_b128 v[20:23], v1 offset:17024
    v_mfma_f32_16x16x32_bf16 v[36:39], v[24:27], v[164:167], v[36:39]
    s_waitcnt vmcnt(6) lgkmcnt(1)
    ds_read_b64_tr_b16 v[176:177], v2 offset:2048
    v_mfma_f32_16x16x32_bf16 v[44:47], v[24:27], v[168:171], v[44:47]
    ds_read_b64_tr_b16 v[178:179], v2 offset:2304
    s_add_u32 m0, s29, 0
    v_mfma_f32_16x16x32_bf16 v[52:55], v[24:27], v[172:175], v[52:55]
    buffer_load_dwordx4 v4, s[12:15], s74 offen lds
    v_mfma_f32_16x16x32_bf16 v[32:35], v[16:19], v[160:163], v[32:35]
    ds_read_b128 v[24:27], v1 offset:25472
    v_mfma_f32_16x16x32_bf16 v[40:43], v[16:19], v[164:167], v[40:43]
    ds_read_b64_tr_b16 v[180:181], v7 offset:2048
    v_mfma_f32_16x16x32_bf16 v[48:51], v[16:19], v[168:171], v[48:51]
    ds_read_b64_tr_b16 v[182:183], v7 offset:2304
    s_add_u32 m0, s29, 1024
    v_mfma_f32_16x16x32_bf16 v[56:59], v[16:19], v[172:175], v[56:59]
    s_waitcnt lgkmcnt(5)
    buffer_load_dwordx4 v4, s[12:15], s75 offen lds
    v_mfma_f32_16x16x32_bf16 v[60:63], v[20:23], v[160:163], v[60:63]
    ds_read_b128 v[16:19], v1 offset:192
    v_mfma_f32_16x16x32_bf16 v[68:71], v[20:23], v[164:167], v[68:71]
    s_waitcnt vmcnt(6)
    ds_read_b64_tr_b16 v[184:185], v2 offset:4096
    v_mfma_f32_16x16x32_bf16 v[76:79], v[20:23], v[168:171], v[76:79]
    ds_read_b64_tr_b16 v[186:187], v2 offset:4352
    s_add_u32 m0, s29, 1536
    v_mfma_f32_16x16x32_bf16 v[84:87], v[20:23], v[172:175], v[84:87]
    s_waitcnt lgkmcnt(5)
    s_waitcnt lgkmcnt(3)
    buffer_load_dwordx4 v4, s[12:15], s74 offen offset:512 lds
    v_mfma_f32_16x16x32_bf16 v[64:67], v[24:27], v[160:163], v[64:67]
    ds_read_b128 v[20:23], v1 offset:8640
    ds_read_b64_tr_b16 v[188:189], v7 offset:4096
    v_mfma_f32_16x16x32_bf16 v[72:75], v[24:27], v[164:167], v[72:75]
    ds_read_b64_tr_b16 v[190:191], v7 offset:4352
    v_mfma_f32_16x16x32_bf16 v[80:83], v[24:27], v[168:171], v[80:83]
    s_add_u32 m0, s29, 2560
    v_mfma_f32_16x16x32_bf16 v[88:91], v[24:27], v[172:175], v[88:91]
    s_waitcnt lgkmcnt(5)
    buffer_load_dwordx4 v4, s[12:15], s75 offen offset:512 lds
    v_mfma_f32_16x16x32_bf16 v[28:31], v[16:19], v[176:179], v[28:31]
    ds_read_b128 v[24:27], v1 offset:17088
    v_mfma_f32_16x16x32_bf16 v[36:39], v[16:19], v[180:183], v[36:39]
    s_waitcnt vmcnt(6) lgkmcnt(1)
    L_pad0:
    s_cbranch_execz L_ret0
    ds_read_b64_tr_b16 v[192:193], v2 offset:6144
    v_mfma_f32_16x16x32_bf16 v[44:47], v[16:19], v[184:187], v[44:47]
    ds_read_b64_tr_b16 v[194:195], v2 offset:6400
    s_add_u32 m0, s29, 4096
    v_mfma_f32_16x16x32_bf16 v[52:55], v[16:19], v[188:191], v[52:55]
    buffer_load_dwordx4 v4, s[12:15], s76 offen lds
    v_mfma_f32_16x16x32_bf16 v[32:35], v[20:23], v[176:179], v[32:35]
    ds_read_b128 v[16:19], v1 offset:25536
    v_mfma_f32_16x16x32_bf16 v[40:43], v[20:23], v[180:183], v[40:43]
    ds_read_b64_tr_b16 v[196:197], v7 offset:6144
    v_mfma_f32_16x16x32_bf16 v[48:51], v[20:23], v[184:187], v[48:51]
    ds_read_b64_tr_b16 v[198:199], v7 offset:6400
    s_add_u32 m0, s29, 5120
    v_mfma_f32_16x16x32_bf16 v[56:59], v[20:23], v[188:191], v[56:59]
    s_waitcnt lgkmcnt(5)
    buffer_load_dwordx4 v4, s[12:15], s77 offen lds
    v_mfma_f32_16x16x32_bf16 v[60:63], v[24:27], v[176:179], v[60:63]
    ds_read_b128 v[20:23], v1 offset:256
    v_mfma_f32_16x16x32_bf16 v[68:71], v[24:27], v[180:183], v[68:71]
    s_waitcnt vmcnt(6)
    ds_read_b64_tr_b16 v[200:201], v2 offset:8192
    v_mfma_f32_16x16x32_bf16 v[76:79], v[24:27], v[184:187], v[76:79]
    ds_read_b64_tr_b16 v[202:203], v2 offset:8448
    s_add_u32 m0, s29, 5632
    v_mfma_f32_16x16x32_bf16 v[84:87], v[24:27], v[188:191], v[84:87]
    s_waitcnt lgkmcnt(5)
    s_waitcnt lgkmcnt(3)
    buffer_load_dwordx4 v4, s[12:15], s76 offen offset:512 lds
    v_mfma_f32_16x16x32_bf16 v[64:67], v[16:19], v[176:179], v[64:67]
    ds_read_b128 v[24:27], v1 offset:8704
    ds_read_b64_tr_b16 v[204:205], v7 offset:8192
    v_mfma_f32_16x16x32_bf16 v[72:75], v[16:19], v[180:183], v[72:75]
    ds_read_b64_tr_b16 v[206:207], v7 offset:8448
    v_mfma_f32_16x16x32_bf16 v[80:83], v[16:19], v[184:187], v[80:83]
    s_add_u32 m0, s29, 6656
    v_mfma_f32_16x16x32_bf16 v[88:91], v[16:19], v[188:191], v[88:91]
    s_waitcnt lgkmcnt(5)
    buffer_load_dwordx4 v4, s[12:15], s77 offen offset:512 lds
    v_mfma_f32_16x16x32_bf16 v[28:31], v[20:23], v[192:195], v[28:31]
    ds_read_b128 v[16:19], v1 offset:17152
    v_mfma_f32_16x16x32_bf16 v[36:39], v[20:23], v[196:199], v[36:39]
    s_waitcnt vmcnt(6) lgkmcnt(1)
    ds_read_b64_tr_b16 v[208:209], v2
    v_mfma_f32_16x16x32_bf16 v[44:47], v[20:23], v[200:203], v[44:47]
    ds_read_b64_tr_b16 v[210:211], v2 offset:256
    s_add_u32 m0, s29, 8192
    v_mfma_f32_16x16x32_bf16 v[52:55], v[20:23], v[204:207], v[52:55]
    buffer_load_dwordx4 v4, s[12:15], s78 offen lds
    v_mfma_f32_16x16x32_bf16 v[32:35], v[24:27], v[192:195], v[32:35]
    ds_read_b128 v[20:23], v1 offset:25600
    v_mfma_f32_16x16x32_bf16 v[40:43], v[24:27], v[196:199], v[40:43]
    ds_read_b64_tr_b16 v[212:213], v7
    v_mfma_f32_16x16x32_bf16 v[48:51], v[24:27], v[200:203], v[48:51]
    ds_read_b64_tr_b16 v[214:215], v7 offset:256
    s_add_u32 m0, s29, 9216
    v_mfma_f32_16x16x32_bf16 v[56:59], v[24:27], v[204:207], v[56:59]
    s_waitcnt lgkmcnt(5)
    buffer_load_dwordx4 v4, s[12:15], s79 offen lds
    v_mfma_f32_16x16x32_bf16 v[60:63], v[16:19], v[192:195], v[60:63]
    ds_read_b128 v[24:27], v1 offset:320
    v_mfma_f32_16x16x32_bf16 v[68:71], v[16:19], v[196:199], v[68:71]
    s_waitcnt vmcnt(6)
    ds_read_b64_tr_b16 v[216:217], v2 offset:2048
    v_mfma_f32_16x16x32_bf16 v[76:79], v[16:19], v[200:203], v[76:79]
    ds_read_b64_tr_b16 v[218:219], v2 offset:2304
    s_mov_b32 m0, s29
    s_add_u32 s54, s78, 512
    v_mfma_f32_16x16x32_bf16 v[84:87], v[16:19], v[204:207], v[84:87]
    s_waitcnt lgkmcnt(5)
    s_waitcnt lgkmcnt(3)
    buffer_load_dwordx4 v4, s[12:15], s54 offen lds
    v_mfma_f32_16x16x32_bf16 v[64:67], v[20:23], v[192:195], v[64:67]
    ds_read_b128 v[16:19], v1 offset:8768
    ds_read_b64_tr_b16 v[220:221], v7 offset:2048
    v_mfma_f32_16x16x32_bf16 v[72:75], v[20:23], v[196:199], v[72:75]
    ds_read_b64_tr_b16 v[222:223], v7 offset:2304
    v_mfma_f32_16x16x32_bf16 v[80:83], v[20:23], v[200:203], v[80:83]
    s_add_u32 m0, s29, 512
    v_mfma_f32_16x16x32_bf16 v[88:91], v[20:23], v[204:207], v[88:91]
    s_waitcnt lgkmcnt(5)
    buffer_load_dwordx4 v4, s[12:15], s79 offen offset:512 lds
    s_setprio 2
    s_barrier
    v_mfma_f32_16x16x32_bf16 v[28:31], v[24:27], v[208:211], v[28:31]
    ds_read_b128 v[20:23], v1 offset:17216
    v_mfma_f32_16x16x32_bf16 v[36:39], v[24:27], v[212:215], v[36:39]
    s_waitcnt vmcnt(6) lgkmcnt(1)
    ds_read_b64_tr_b16 v[224:225], v2 offset:4096
    v_mfma_f32_16x16x32_bf16 v[44:47], v[24:27], v[216:219], v[44:47]
    ds_read_b64_tr_b16 v[226:227], v2 offset:4352
    v_mfma_f32_16x16x32_bf16 v[52:55], v[24:27], v[220:223], v[52:55]
    v_mfma_f32_16x16x32_bf16 v[32:35], v[16:19], v[208:211], v[32:35]
    ds_read_b128 v[24:27], v1 offset:25664
    v_mfma_f32_16x16x32_bf16 v[40:43], v[16:19], v[212:215], v[40:43]
    ds_read_b64_tr_b16 v[228:229], v7 offset:4096
    v_mfma_f32_16x16x32_bf16 v[48:51], v[16:19], v[216:219], v[48:51]
    ds_read_b64_tr_b16 v[230:231], v7 offset:4352
    v_mfma_f32_16x16x32_bf16 v[56:59], v[16:19], v[220:223], v[56:59]
    s_waitcnt lgkmcnt(5)
    v_mfma_f32_16x16x32_bf16 v[60:63], v[20:23], v[208:211], v[60:63]
    ds_read_b128 v[16:19], v1 offset:384
    v_mfma_f32_16x16x32_bf16 v[68:71], v[20:23], v[212:215], v[68:71]
    s_waitcnt vmcnt(4)
    ds_read_b64_tr_b16 v[232:233], v2 offset:6144
    v_mfma_f32_16x16x32_bf16 v[76:79], v[20:23], v[216:219], v[76:79]
    ds_read_b64_tr_b16 v[234:235], v2 offset:6400
    v_mfma_f32_16x16x32_bf16 v[84:87], v[20:23], v[220:223], v[84:87]
    s_waitcnt lgkmcnt(5)
    v_mfma_f32_16x16x32_bf16 v[64:67], v[24:27], v[208:211], v[64:67]
    ds_read_b128 v[20:23], v1 offset:8832
    ds_read_b64_tr_b16 v[236:237], v7 offset:6144
    v_mfma_f32_16x16x32_bf16 v[72:75], v[24:27], v[212:215], v[72:75]
    ds_read_b64_tr_b16 v[238:239], v7 offset:6400
    v_mfma_f32_16x16x32_bf16 v[80:83], v[24:27], v[216:219], v[80:83]
    v_mfma_f32_16x16x32_bf16 v[88:91], v[24:27], v[220:223], v[88:91]
    s_waitcnt lgkmcnt(5)
    v_mfma_f32_16x16x32_bf16 v[28:31], v[16:19], v[224:227], v[28:31]
    ds_read_b128 v[24:27], v1 offset:17280
    v_mfma_f32_16x16x32_bf16 v[36:39], v[16:19], v[228:231], v[36:39]
    s_waitcnt vmcnt(2) lgkmcnt(1)
    ds_read_b64_tr_b16 v[240:241], v2 offset:8192
    v_mfma_f32_16x16x32_bf16 v[44:47], v[16:19], v[232:235], v[44:47]
    ds_read_b64_tr_b16 v[242:243], v2 offset:8448
    v_mfma_f32_16x16x32_bf16 v[52:55], v[16:19], v[236:239], v[52:55]
    v_mfma_f32_16x16x32_bf16 v[32:35], v[20:23], v[224:227], v[32:35]
    ds_read_b128 v[16:19], v1 offset:25728
    v_mfma_f32_16x16x32_bf16 v[40:43], v[20:23], v[228:231], v[40:43]
    ds_read_b64_tr_b16 v[244:245], v7 offset:8192
    v_mfma_f32_16x16x32_bf16 v[48:51], v[20:23], v[232:235], v[48:51]
    ds_read_b64_tr_b16 v[246:247], v7 offset:8448
    v_mfma_f32_16x16x32_bf16 v[56:59], v[20:23], v[236:239], v[56:59]
    s_waitcnt lgkmcnt(5)
    v_mfma_f32_16x16x32_bf16 v[60:63], v[24:27], v[224:227], v[60:63]
    ds_read_b128 v[20:23], v1 offset:448
    v_mfma_f32_16x16x32_bf16 v[68:71], v[24:27], v[228:231], v[68:71]
    s_waitcnt vmcnt(0)
    ds_read_b64_tr_b16 v[248:249], v2
    v_mfma_f32_16x16x32_bf16 v[76:79], v[24:27], v[232:235], v[76:79]
    ds_read_b64_tr_b16 v[250:251], v2 offset:256
    v_mfma_f32_16x16x32_bf16 v[84:87], v[24:27], v[236:239], v[84:87]
    s_waitcnt lgkmcnt(5)
    v_mfma_f32_16x16x32_bf16 v[64:67], v[16:19], v[224:227], v[64:67]
    ds_read_b128 v[24:27], v1 offset:8896
    ds_read_b64_tr_b16 v[252:253], v7
    v_mfma_f32_16x16x32_bf16 v[72:75], v[16:19], v[228:231], v[72:75]
    ds_read_b64_tr_b16 v[254:255], v7 offset:256
    v_mfma_f32_16x16x32_bf16 v[80:83], v[16:19], v[232:235], v[80:83]
    v_mfma_f32_16x16x32_bf16 v[88:91], v[16:19], v[236:239], v[88:91]
    s_waitcnt lgkmcnt(5)
    v_mfma_f32_16x16x32_bf16 v[28:31], v[20:23], v[240:243], v[28:31]
    ds_read_b128 v[16:19], v1 offset:17344
    v_mfma_f32_16x16x32_bf16 v[36:39], v[20:23], v[244:247], v[36:39]
    s_waitcnt lgkmcnt(1)
    v_mfma_f32_16x16x32_bf16 v[44:47], v[20:23], v[248:251], v[44:47]
    v_mfma_f32_16x16x32_bf16 v[52:55], v[20:23], v[252:255], v[52:55]
    v_mfma_f32_16x16x32_bf16 v[32:35], v[24:27], v[240:243], v[32:35]
    ds_read_b128 v[20:23], v1 offset:25792
    v_mfma_f32_16x16x32_bf16 v[40:43], v[24:27], v[244:247], v[40:43]
    v_mfma_f32_16x16x32_bf16 v[48:51], v[24:27], v[248:251], v[48:51]
    v_mfma_f32_16x16x32_bf16 v[56:59], v[24:27], v[252:255], v[56:59]
    s_waitcnt lgkmcnt(1)
    v_mfma_f32_16x16x32_bf16 v[60:63], v[16:19], v[240:243], v[60:63]
    v_mfma_f32_16x16x32_bf16 v[68:71], v[16:19], v[244:247], v[68:71]
    v_mfma_f32_16x16x32_bf16 v[76:79], v[16:19], v[248:251], v[76:79]
    v_mfma_f32_16x16x32_bf16 v[84:87], v[16:19], v[252:255], v[84:87]
    s_waitcnt lgkmcnt(0)
    v_mfma_f32_16x16x32_bf16 v[64:67], v[20:23], v[240:243], v[64:67]
    v_mfma_f32_16x16x32_bf16 v[72:75], v[20:23], v[244:247], v[72:75]
    v_mfma_f32_16x16x32_bf16 v[80:83], v[20:23], v[248:251], v[80:83]
    v_mfma_f32_16x16x32_bf16 v[88:91], v[20:23], v[252:255], v[88:91]
    s_setprio 0
    s_nop 0
    v_mul_f32 v76, v8, v76
    v_mul_f32 v77, v8, v77
    v_exp_f32 v76, v76
    v_exp_f32 v77, v77
    v_mul_f32 v78, v8, v78
    v_mul_f32 v79, v8, v79
    v_exp_f32 v78, v78
    v_exp_f32 v79, v79
    v_fmaak_f32 v76, v76, v9, 0xbf317218
    v_fmaak_f32 v77, v77, v9, 0xbf317218
    v_rcp_f32 v76, v76
    v_rcp_f32 v77, v77
    v_fmaak_f32 v78, v78, v9, 0xbf317218
    v_fmaak_f32 v79, v79, v9, 0xbf317218
    v_rcp_f32 v78, v78
    v_rcp_f32 v79, v79
    v_mul_f32 v60, v60, v76
    v_mul_f32 v61, v61, v77
    v_cvt_pk_bf16_f32 v60, v60, v61
    v_mul_f32 v62, v62, v78
    v_mul_f32 v63, v63, v79
    v_cvt_pk_bf16_f32 v61, v62, v63
    v_mul_f32 v80, v8, v80
    v_mul_f32 v81, v8, v81
    v_exp_f32 v80, v80
    v_exp_f32 v81, v81
    v_mul_f32 v82, v8, v82
    v_mul_f32 v83, v8, v83
    v_exp_f32 v82, v82
    v_exp_f32 v83, v83
    v_fmaak_f32 v80, v80, v9, 0xbf317218
    v_fmaak_f32 v81, v81, v9, 0xbf317218
    v_rcp_f32 v80, v80
    v_rcp_f32 v81, v81
    v_fmaak_f32 v82, v82, v9, 0xbf317218
    v_fmaak_f32 v83, v83, v9, 0xbf317218
    v_rcp_f32 v82, v82
    v_rcp_f32 v83, v83
    v_mul_f32 v64, v64, v80
    v_mul_f32 v65, v65, v81
    v_cvt_pk_bf16_f32 v62, v64, v65
    v_mul_f32 v66, v66, v82
    v_mul_f32 v67, v67, v83
    v_cvt_pk_bf16_f32 v63, v66, v67
    v_mul_f32 v84, v8, v84
    v_mul_f32 v85, v8, v85
    v_exp_f32 v84, v84
    v_exp_f32 v85, v85
    v_mul_f32 v86, v8, v86
    v_mul_f32 v87, v8, v87
    v_exp_f32 v86, v86
    v_exp_f32 v87, v87
    v_fmaak_f32 v84, v84, v9, 0xbf317218
    v_fmaak_f32 v85, v85, v9, 0xbf317218
    v_rcp_f32 v84, v84
    v_rcp_f32 v85, v85
    v_fmaak_f32 v86, v86, v9, 0xbf317218
    v_fmaak_f32 v87, v87, v9, 0xbf317218
    v_rcp_f32 v86, v86
    v_rcp_f32 v87, v87
    v_mul_f32 v68, v68, v84
    v_mul_f32 v69, v69, v85
    v_cvt_pk_bf16_f32 v64, v68, v69
    v_mul_f32 v70, v70, v86
    v_mul_f32 v71, v71, v87
    v_cvt_pk_bf16_f32 v65, v70, v71
    v_mul_f32 v88, v8, v88
    v_mul_f32 v89, v8, v89
    v_exp_f32 v88, v88
    v_exp_f32 v89, v89
    v_mul_f32 v90, v8, v90
    v_mul_f32 v91, v8, v91
    v_exp_f32 v90, v90
    v_exp_f32 v91, v91
    v_fmaak_f32 v88, v88, v9, 0xbf317218
    v_fmaak_f32 v89, v89, v9, 0xbf317218
    v_rcp_f32 v88, v88
    v_rcp_f32 v89, v89
    v_fmaak_f32 v90, v90, v9, 0xbf317218
    v_fmaak_f32 v91, v91, v9, 0xbf317218
    v_rcp_f32 v90, v90
    v_rcp_f32 v91, v91
    v_mul_f32 v72, v72, v88
    v_mul_f32 v73, v73, v89
    v_cvt_pk_bf16_f32 v66, v72, v73
    v_mul_f32 v74, v74, v90
    v_mul_f32 v75, v75, v91
    v_cvt_pk_bf16_f32 v67, v74, v75
    ds_read_b128 v[76:79], v12
    ds_read_b128 v[80:83], v12 offset:1024
    ds_read_b128 v[84:87], v12 offset:2048
    v_mul_f32 v44, v8, v44
    v_mul_f32 v45, v8, v45
    v_exp_f32 v44, v44
    v_exp_f32 v45, v45
    v_mul_f32 v46, v8, v46
    v_mul_f32 v47, v8, v47
    v_exp_f32 v46, v46
    v_exp_f32 v47, v47
    v_fmaak_f32 v44, v44, v9, 0xbf317218
    v_fmaak_f32 v45, v45, v9, 0xbf317218
    v_rcp_f32 v44, v44
    v_rcp_f32 v45, v45
    v_fmaak_f32 v46, v46, v9, 0xbf317218
    v_fmaak_f32 v47, v47, v9, 0xbf317218
    v_rcp_f32 v46, v46
    v_rcp_f32 v47, v47
    v_mul_f32 v28, v28, v44
    v_mul_f32 v29, v29, v45
    v_cvt_pk_bf16_f32 v28, v28, v29
    v_mul_f32 v30, v30, v46
    v_mul_f32 v31, v31, v47
    v_cvt_pk_bf16_f32 v29, v30, v31
    v_mul_f32 v48, v8, v48
    v_mul_f32 v49, v8, v49
    v_exp_f32 v48, v48
    v_exp_f32 v49, v49
    v_mul_f32 v50, v8, v50
    v_mul_f32 v51, v8, v51
    v_exp_f32 v50, v50
    v_exp_f32 v51, v51
    v_fmaak_f32 v48, v48, v9, 0xbf317218
    v_fmaak_f32 v49, v49, v9, 0xbf317218
    v_rcp_f32 v48, v48
    v_rcp_f32 v49, v49
    v_fmaak_f32 v50, v50, v9, 0xbf317218
    v_fmaak_f32 v51, v51, v9, 0xbf317218
    v_rcp_f32 v50, v50
    v_rcp_f32 v51, v51
    v_mul_f32 v32, v32, v48
    v_mul_f32 v33, v33, v49
    v_cvt_pk_bf16_f32 v30, v32, v33
    v_mul_f32 v34, v34, v50
    v_mul_f32 v35, v35, v51
    v_cvt_pk_bf16_f32 v31, v34, v35
    s_lshl_b32 s55, s32, 2
    s_add_u32 s55, s55, 1048576
    s_sub_u32 s55, s55, s29
    buffer_store_dwordx4 v[28:31], v6, s[4:7], s55 offen sc1
    s_waitcnt lgkmcnt(0)
    s_barrier
    s_mul_i32 s60, s28, 0x2400
    s_and_b32 s60, s60, 0x2800
    s_add_u32 s60, s60, 32768
    s_mul_i32 s31, s28, 4224
    s_add_u32 m0, s31, 115712
    s_nop 0
    buffer_load_dwordx4 v3, s[8:11], s60 offen nt lds
    s_add_u32 m0, s31, 116256
    s_nop 0
    buffer_load_dwordx4 v3, s[8:11], s60 offen offset:512 nt lds
    s_add_u32 m0, s31, 116800
    s_nop 0
    buffer_load_dwordx4 v3, s[8:11], s60 offen offset:1024 nt lds
    s_add_u32 m0, s31, 117344
    s_nop 0
    buffer_load_dwordx4 v3, s[8:11], s60 offen offset:1536 nt lds
    v_bfe_u32 v15, v11, 2, 8
    s_add_u32 s53, s32, 6291456
    buffer_load_dword v13, v15, s[4:7], s53 offen sc1
    s_add_u32 s53, s33, 6291456
    buffer_load_dword v14, v15, s[4:7], s53 offen sc1
    v_mul_f32 v52, v8, v52
    v_mul_f32 v53, v8, v53
    v_exp_f32 v52, v52
    v_exp_f32 v53, v53
    v_mul_f32 v54, v8, v54
    v_mul_f32 v55, v8, v55
    v_exp_f32 v54, v54
    v_exp_f32 v55, v55
    v_fmaak_f32 v52, v52, v9, 0xbf317218
    v_fmaak_f32 v53, v53, v9, 0xbf317218
    v_rcp_f32 v52, v52
    v_rcp_f32 v53, v53
    v_fmaak_f32 v54, v54, v9, 0xbf317218
    v_fmaak_f32 v55, v55, v9, 0xbf317218
    v_rcp_f32 v54, v54
    v_rcp_f32 v55, v55
    v_mul_f32 v36, v36, v52
    v_mul_f32 v37, v37, v53
    v_cvt_pk_bf16_f32 v32, v36, v37
    v_mul_f32 v38, v38, v54
    v_mul_f32 v39, v39, v55
    v_cvt_pk_bf16_f32 v33, v38, v39
    v_mul_f32 v56, v8, v56
    v_mul_f32 v57, v8, v57
    v_exp_f32 v56, v56
    v_exp_f32 v57, v57
    v_mul_f32 v58, v8, v58
    v_mul_f32 v59, v8, v59
    v_exp_f32 v58, v58
    v_exp_f32 v59, v59
    v_fmaak_f32 v56, v56, v9, 0xbf317218
    v_fmaak_f32 v57, v57, v9, 0xbf317218
    v_rcp_f32 v56, v56
    v_rcp_f32 v57, v57
    v_fmaak_f32 v58, v58, v9, 0xbf317218
    v_fmaak_f32 v59, v59, v9, 0xbf317218
    v_rcp_f32 v58, v58
    v_rcp_f32 v59, v59
    v_mul_f32 v40, v40, v56
    v_mul_f32 v41, v41, v57
    v_cvt_pk_bf16_f32 v34, v40, v41
    v_mul_f32 v42, v42, v58
    v_mul_f32 v43, v43, v59
    v_cvt_pk_bf16_f32 v35, v42, v43
    buffer_store_dwordx4 v[32:35], v6, s[4:7], s55 offen offset:256 sc1
    v_bfe_u32 v7, v11, 2, 8
    ds_write_b128 v6, v[60:63] offset:2048
    ds_write_b128 v6, v[64:67] offset:2304
    ds_write_b128 v6, v[28:31]
    ds_write_b128 v6, v[32:35] offset:256
    ds_read_b128 v[28:31], v76
    ds_read_b128 v[32:35], v77
    ds_read_b128 v[36:39], v78
    ds_read_b128 v[40:43], v79
    ds_read_b128 v[44:47], v76 offset:2048
    ds_read_b128 v[48:51], v76 offset:256
    ds_read_b128 v[52:55], v77 offset:256
    ds_read_b128 v[56:59], v78 offset:256
    ds_read_b128 v[16:19], v79 offset:256
    ds_read_b128 v[20:23], v76 offset:2304
    s_waitcnt lgkmcnt(9)
    v_mfma_f32_4x4x4_16b_bf16 v[60:63], v[92:93], v[28:29], 0
    v_mfma_f32_4x4x4_16b_bf16 v[64:67], v[92:93], v[30:31], 0
    s_waitcnt lgkmcnt(4)
    v_mfma_f32_4x4x4_16b_bf16 v[68:71], v[110:111], v[48:49], 0
    v_mfma_f32_4x4x4_16b_bf16 v[72:75], v[110:111], v[50:51], 0
    v_mfma_f32_4x4x4_16b_bf16 v[60:63], v[94:95], v[30:31], v[60:63]
    v_mfma_f32_4x4x4_16b_bf16 v[64:67], v[94:95], v[32:33], v[64:67]
    v_mfma_f32_4x4x4_16b_bf16 v[68:71], v[112:113], v[50:51], v[68:71]
    s_waitcnt lgkmcnt(3)
    v_mfma_f32_4x4x4_16b_bf16 v[72:75], v[112:113], v[52:53], v[72:75]
    v_mfma_f32_4x4x4_16b_bf16 v[60:63], v[96:97], v[32:33], v[60:63]
    v_mfma_f32_4x4x4_16b_bf16 v[64:67], v[96:97], v[34:35], v[64:67]
    v_mfma_f32_4x4x4_16b_bf16 v[68:71], v[114:115], v[52:53], v[68:71]
    v_mfma_f32_4x4x4_16b_bf16 v[72:75], v[114:115], v[54:55], v[72:75]
    v_mfma_f32_4x4x4_16b_bf16 v[60:63], v[98:99], v[34:35], v[60:63]
    v_mfma_f32_4x4x4_16b_bf16 v[64:67], v[98:99], v[36:37], v[64:67]
    v_mfma_f32_4x4x4_16b_bf16 v[68:71], v[116:117], v[54:55], v[68:71]
    s_waitcnt lgkmcnt(2)
    v_mfma_f32_4x4x4_16b_bf16 v[72:75], v[116:117], v[56:57], v[72:75]
    v_mfma_f32_4x4x4_16b_bf16 v[60:63], v[100:101], v[36:37], v[60:63]
    v_mfma_f32_4x4x4_16b_bf16 v[64:67], v[100:101], v[38:39], v[64:67]
    v_mfma_f32_4x4x4_16b_bf16 v[68:71], v[118:119], v[56:57], v[68:71]
    v_mfma_f32_4x4x4_16b_bf16 v[72:75], v[118:119], v[58:59], v[72:75]
    v_mfma_f32_4x4x4_16b_bf16 v[60:63], v[102:103], v[38:39], v[60:63]
    v_mfma_f32_4x4x4_16b_bf16 v[64:67], v[102:103], v[40:41], v[64:67]
    v_mfma_f32_4x4x4_16b_bf16 v[68:71], v[120:121], v[58:59], v[68:71]
    s_waitcnt lgkmcnt(1)
    v_mfma_f32_4x4x4_16b_bf16 v[72:75], v[120:121], v[16:17], v[72:75]
    v_mfma_f32_4x4x4_16b_bf16 v[60:63], v[104:105], v[40:41], v[60:63]
    v_mfma_f32_4x4x4_16b_bf16 v[64:67], v[104:105], v[42:43], v[64:67]
    v_mfma_f32_4x4x4_16b_bf16 v[68:71], v[122:123], v[16:17], v[68:71]
    v_mfma_f32_4x4x4_16b_bf16 v[72:75], v[122:123], v[18:19], v[72:75]
    v_mfma_f32_4x4x4_16b_bf16 v[60:63], v[106:107], v[42:43], v[60:63]
    v_mfma_f32_4x4x4_16b_bf16 v[64:67], v[106:107], v[44:45], v[64:67]
    v_mfma_f32_4x4x4_16b_bf16 v[68:71], v[124:125], v[18:19], v[68:71]
    s_waitcnt lgkmcnt(0)
    v_mfma_f32_4x4x4_16b_bf16 v[72:75], v[124:125], v[20:21], v[72:75]
    v_mfma_f32_4x4x4_16b_bf16 v[60:63], v[108:109], v[44:45], v[60:63]
    v_mfma_f32_4x4x4_16b_bf16 v[64:67], v[108:109], v[46:47], v[64:67]
    v_mfma_f32_4x4x4_16b_bf16 v[68:71], v[126:127], v[20:21], v[68:71]
    v_mfma_f32_4x4x4_16b_bf16 v[72:75], v[126:127], v[22:23], v[72:75]
    s_nop 1
    v_exp_f32 v0, v60
    v_exp_f32 v15, v61
    v_fmaak_f32 v0, v0, v8, 0xbfb8aa3b
    v_fmaak_f32 v15, v15, v8, 0xbfb8aa3b
    v_rcp_f32 v0, v0
    v_rcp_f32 v15, v15
    v_mul_f32 v60, v60, v0
    v_mul_f32 v61, v61, v15
    v_exp_f32 v87, v62
    v_exp_f32 v4, v63
    v_fmaak_f32 v87, v87, v8, 0xbfb8aa3b
    v_fmaak_f32 v4, v4, v8, 0xbfb8aa3b
    v_rcp_f32 v87, v87
    v_rcp_f32 v4, v4
    v_mul_f32 v62, v62, v87
    v_mul_f32 v63, v63, v4
    v_exp_f32 v0, v64
    v_exp_f32 v15, v65
    v_fmaak_f32 v0, v0, v8, 0xbfb8aa3b
    v_fmaak_f32 v15, v15, v8, 0xbfb8aa3b
    v_rcp_f32 v0, v0
    v_rcp_f32 v15, v15
    v_mul_f32 v64, v64, v0
    v_mul_f32 v65, v65, v15
    v_exp_f32 v87, v66
    v_exp_f32 v4, v67
    v_fmaak_f32 v87, v87, v8, 0xbfb8aa3b
    v_fmaak_f32 v4, v4, v8, 0xbfb8aa3b
    v_rcp_f32 v87, v87
    v_rcp_f32 v4, v4
    v_mul_f32 v66, v66, v87
    v_mul_f32 v67, v67, v4
    v_cvt_pk_bf16_f32 v60, v60, v61
    v_cvt_pk_bf16_f32 v61, v62, v63
    v_cvt_pk_bf16_f32 v62, v64, v65
    v_cvt_pk_bf16_f32 v63, v66, v67
    s_add_u32 s60, s60, 16384
    s_add_u32 m0, s31, 132608
    s_nop 0
    buffer_load_dwordx4 v3, s[8:11], s60 offen nt lds
    s_add_u32 m0, s31, 133152
    s_nop 0
    buffer_load_dwordx4 v3, s[8:11], s60 offen offset:512 nt lds
    s_add_u32 m0, s31, 133696
    s_nop 0
    buffer_load_dwordx4 v3, s[8:11], s60 offen offset:1024 nt lds
    s_add_u32 m0, s31, 134240
    s_nop 0
    buffer_load_dwordx4 v3, s[8:11], s60 offen offset:1536 nt lds
    buffer_load_dword v12, v11, s[20:23], s62 offen
    v_exp_f32 v0, v68
    v_exp_f32 v15, v69
    v_fmaak_f32 v0, v0, v8, 0xbfb8aa3b
    v_fmaak_f32 v15, v15, v8, 0xbfb8aa3b
    v_rcp_f32 v0, v0
    v_rcp_f32 v15, v15
    v_mul_f32 v68, v68, v0
    v_mul_f32 v69, v69, v15
    v_exp_f32 v87, v70
    v_exp_f32 v4, v71
    v_fmaak_f32 v87, v87, v8, 0xbfb8aa3b
    v_fmaak_f32 v4, v4, v8, 0xbfb8aa3b
    v_rcp_f32 v87, v87
    v_rcp_f32 v4, v4
    v_mul_f32 v70, v70, v87
    v_mul_f32 v71, v71, v4
    v_exp_f32 v0, v72
    v_exp_f32 v15, v73
    v_fmaak_f32 v0, v0, v8, 0xbfb8aa3b
    v_fmaak_f32 v15, v15, v8, 0xbfb8aa3b
    v_rcp_f32 v0, v0
    v_rcp_f32 v15, v15
    v_mul_f32 v72, v72, v0
    v_mul_f32 v73, v73, v15
    v_exp_f32 v87, v74
    v_exp_f32 v4, v75
    v_fmaak_f32 v87, v87, v8, 0xbfb8aa3b
    v_fmaak_f32 v4, v4, v8, 0xbfb8aa3b
    v_rcp_f32 v87, v87
    v_rcp_f32 v4, v4
    v_mul_f32 v74, v74, v87
    v_mul_f32 v75, v75, v4
    v_cvt_pk_bf16_f32 v68, v68, v69
    v_cvt_pk_bf16_f32 v69, v70, v71
    v_cvt_pk_bf16_f32 v70, v72, v73
    v_cvt_pk_bf16_f32 v71, v74, v75
    s_waitcnt vmcnt(8)
    s_barrier
    ds_read_b128 v[16:19], v1 offset:33792
    ds_read_b128 v[20:23], v1 offset:33856
    s_waitcnt lgkmcnt(1)
    v_mfma_f32_16x16x32_bf16 v[28:31], v[16:19], v[128:131], 0
    ds_read_b128 v[24:27], v1 offset:42240
    s_waitcnt lgkmcnt(1)
    v_mfma_f32_16x16x32_bf16 v[28:31], v[20:23], v[144:147], v[28:31]
    v_mfma_f32_16x16x32_bf16 v[36:39], v[16:19], v[132:135], 0
    ds_read_b128 v[88:91], v1 offset:42304
    v_mfma_f32_16x16x32_bf16 v[36:39], v[20:23], v[148:151], v[36:39]
    v_mfma_f32_16x16x32_bf16 v[44:47], v[16:19], v[136:139], 0
    v_mfma_f32_16x16x32_bf16 v[44:47], v[20:23], v[152:155], v[44:47]
    v_mfma_f32_16x16x32_bf16 v[52:55], v[16:19], v[140:143], 0
    v_mfma_f32_16x16x32_bf16 v[52:55], v[20:23], v[156:159], v[52:55]
    s_waitcnt lgkmcnt(0)
    v_mfma_f32_16x16x32_bf16 v[32:35], v[24:27], v[128:131], 0
    ds_read_b128 v[16:19], v1 offset:33920
    v_mfma_f32_16x16x32_bf16 v[32:35], v[88:91], v[144:147], v[32:35]
    v_mfma_f32_16x16x32_bf16 v[40:43], v[24:27], v[132:135], 0
    ds_read_b128 v[20:23], v1 offset:33984
    v_mfma_f32_16x16x32_bf16 v[40:43], v[88:91], v[148:151], v[40:43]
    v_mfma_f32_16x16x32_bf16 v[48:51], v[24:27], v[136:139], 0
    v_mfma_f32_16x16x32_bf16 v[48:51], v[88:91], v[152:155], v[48:51]
    v_mfma_f32_16x16x32_bf16 v[56:59], v[24:27], v[140:143], 0
    v_mfma_f32_16x16x32_bf16 v[56:59], v[88:91], v[156:159], v[56:59]
    s_waitcnt lgkmcnt(0)
    v_mfma_f32_16x16x32_bf16 v[28:31], v[16:19], v[160:163], v[28:31]
    ds_read_b128 v[24:27], v1 offset:42368
    v_mfma_f32_16x16x32_bf16 v[28:31], v[20:23], v[176:179], v[28:31]
    v_mfma_f32_16x16x32_bf16 v[36:39], v[16:19], v[164:167], v[36:39]
    ds_read_b128 v[88:91], v1 offset:42432
    v_mfma_f32_16x16x32_bf16 v[36:39], v[20:23], v[180:183], v[36:39]
    s_waitcnt vmcnt(7)
    v_add_u32 v13, 2654435769, v13
    s_add_u32 s53, s32, 6291712
    s_waitcnt vmcnt(5)
    buffer_store_dword v13, v7, s[4:7], s53 offen sc1
    v_mfma_f32_16x16x32_bf16 v[44:47], v[16:19], v[168:171], v[44:47]
    v_mfma_f32_16x16x32_bf16 v[44:47], v[20:23], v[184:187], v[44:47]
    ds_write_b128 v80, v[60:63]
    v_mfma_f32_16x16x32_bf16 v[52:55], v[16:19], v[172:175], v[52:55]
    v_mfma_f32_16x16x32_bf16 v[52:55], v[20:23], v[188:191], v[52:55]
    s_waitcnt lgkmcnt(1)
    v_mfma_f32_16x16x32_bf16 v[32:35], v[24:27], v[160:163], v[32:35]
    ds_read_b128 v[16:19], v1 offset:34048
    v_mfma_f32_16x16x32_bf16 v[32:35], v[88:91], v[176:179], v[32:35]
    v_mfma_f32_16x16x32_bf16 v[40:43], v[24:27], v[164:167], v[40:43]
    ds_read_b128 v[20:23], v1 offset:34112
    v_mfma_f32_16x16x32_bf16 v[40:43], v[88:91], v[180:183], v[40:43]
    v_mfma_f32_16x16x32_bf16 v[48:51], v[24:27], v[168:171], v[48:51]
    v_mfma_f32_16x16x32_bf16 v[48:51], v[88:91], v[184:187], v[48:51]
    ds_write_b128 v80, v[68:71] offset:1024
    v_mfma_f32_16x16x32_bf16 v[56:59], v[24:27], v[172:175], v[56:59]
    v_mfma_f32_16x16x32_bf16 v[56:59], v[88:91], v[188:191], v[56:59]
    s_waitcnt lgkmcnt(1)
    v_mfma_f32_16x16x32_bf16 v[28:31], v[16:19], v[192:195], v[28:31]
    ds_read_b128 v[24:27], v1 offset:42496
    v_mfma_f32_16x16x32_bf16 v[28:31], v[20:23], v[208:211], v[28:31]
    v_mfma_f32_16x16x32_bf16 v[36:39], v[16:19], v[196:199], v[36:39]
    ds_read_b128 v[88:91], v1 offset:42560
    v_mfma_f32_16x16x32_bf16 v[36:39], v[20:23], v[212:215], v[36:39]
    v_mfma_f32_16x16x32_bf16 v[44:47], v[16:19], v[200:203], v[44:47]
    v_mfma_f32_16x16x32_bf16 v[44:47], v[20:23], v[216:219], v[44:47]
    v_mfma_f32_16x16x32_bf16 v[52:55], v[16:19], v[204:207], v[52:55]
    v_mfma_f32_16x16x32_bf16 v[52:55], v[20:23], v[220:223], v[52:55]
    s_waitcnt lgkmcnt(0)
    v_mfma_f32_16x16x32_bf16 v[32:35], v[24:27], v[192:195], v[32:35]
    ds_read_b128 v[16:19], v1 offset:34176
    v_mfma_f32_16x16x32_bf16 v[32:35], v[88:91], v[208:211], v[32:35]
    v_mfma_f32_16x16x32_bf16 v[40:43], v[24:27], v[196:199], v[40:43]
    ds_read_b128 v[20:23], v1 offset:34240
    v_mfma_f32_16x16x32_bf16 v[40:43], v[88:91], v[212:215], v[40:43]
    v_mfma_f32_16x16x32_bf16 v[48:51], v[24:27], v[200:203], v[48:51]
    v_mfma_f32_16x16x32_bf16 v[48:51], v[88:91], v[216:219], v[48:51]
    v_mfma_f32_16x16x32_bf16 v[56:59], v[24:27], v[204:207], v[56:59]
    v_mfma_f32_16x16x32_bf16 v[56:59], v[88:91], v[220:223], v[56:59]
    s_waitcnt lgkmcnt(0)
    v_mfma_f32_16x16x32_bf16 v[28:31], v[16:19], v[224:227], v[28:31]
    ds_read_b128 v[24:27], v1 offset:42624
    v_mfma_f32_16x16x32_bf16 v[28:31], v[20:23], v[240:243], v[28:31]
    v_mfma_f32_16x16x32_bf16 v[36:39], v[16:19], v[228:231], v[36:39]
    ds_read_b128 v[88:91], v1 offset:42688
    v_mfma_f32_16x16x32_bf16 v[36:39], v[20:23], v[244:247], v[36:39]
    v_mfma_f32_16x16x32_bf16 v[44:47], v[16:19], v[232:235], v[44:47]
    v_mfma_f32_16x16x32_bf16 v[44:47], v[20:23], v[248:251], v[44:47]
    v_mfma_f32_16x16x32_bf16 v[52:55], v[16:19], v[236:239], v[52:55]
    v_mfma_f32_16x16x32_bf16 v[52:55], v[20:23], v[252:255], v[52:55]
    s_waitcnt lgkmcnt(0)
    v_mfma_f32_16x16x32_bf16 v[32:35], v[24:27], v[224:227], v[32:35]
    v_mfma_f32_16x16x32_bf16 v[32:35], v[88:91], v[240:243], v[32:35]
    v_mfma_f32_16x16x32_bf16 v[40:43], v[24:27], v[228:231], v[40:43]
    v_mfma_f32_16x16x32_bf16 v[40:43], v[88:91], v[244:247], v[40:43]
    v_mfma_f32_16x16x32_bf16 v[48:51], v[24:27], v[232:235], v[48:51]
    v_mfma_f32_16x16x32_bf16 v[48:51], v[88:91], v[248:251], v[48:51]
    v_mfma_f32_16x16x32_bf16 v[56:59], v[24:27], v[236:239], v[56:59]
    v_mfma_f32_16x16x32_bf16 v[56:59], v[88:91], v[252:255], v[56:59]
    v_mul_f32 v44, v8, v44
    s_add_u32 m0, s29, 6144
    v_mul_f32 v45, v8, v45
    buffer_load_dwordx4 v5, s[20:23], s36 offen lds
    v_exp_f32 v44, v44
    v_exp_f32 v45, v45
    v_mul_f32 v46, v8, v46
    v_mul_f32 v47, v8, v47
    v_exp_f32 v46, v46
    v_exp_f32 v47, v47
    v_fmaak_f32 v44, v44, v9, 0xbf317218
    s_add_u32 m0, s29, 6144
    v_fmaak_f32 v45, v45, v9, 0xbf317218
    L_pad1:
    s_cbranch_execz L_ret0
    buffer_load_dwordx4 v5, s[20:23], s37 offen offset:1024 lds
    v_rcp_f32 v44, v44
    v_rcp_f32 v45, v45
    v_fmaak_f32 v46, v46, v9, 0xbf317218
    v_fmaak_f32 v47, v47, v9, 0xbf317218
    v_rcp_f32 v46, v46
    v_rcp_f32 v47, v47
    v_mul_f32 v28, v28, v44
    s_add_u32 m0, s29, 0
    v_mul_f32 v29, v29, v45
    buffer_load_dwordx4 v5, s[20:23], s38 offen lds
    v_cvt_pk_bf16_f32 v60, v28, v29
    v_mul_f32 v30, v30, v46
    v_mul_f32 v31, v31, v47
    v_cvt_pk_bf16_f32 v61, v30, v31
    v_mul_f32 v48, v8, v48
    v_mul_f32 v49, v8, v49
    v_exp_f32 v48, v48
    s_add_u32 m0, s29, 0
    v_exp_f32 v49, v49
    buffer_load_dwordx4 v5, s[20:23], s39 offen offset:1024 lds
    v_mul_f32 v50, v8, v50
    v_mul_f32 v51, v8, v51
    v_exp_f32 v50, v50
    v_exp_f32 v51, v51
    v_fmaak_f32 v48, v48, v9, 0xbf317218
    v_fmaak_f32 v49, v49, v9, 0xbf317218
    v_rcp_f32 v48, v48
    s_add_u32 m0, s30, 0
    v_rcp_f32 v49, v49
    buffer_load_dwordx4 v5, s[20:23], s40 offen lds
    v_fmaak_f32 v50, v50, v9, 0xbf317218
    v_fmaak_f32 v51, v51, v9, 0xbf317218
    v_rcp_f32 v50, v50
    v_rcp_f32 v51, v51
    v_mul_f32 v32, v32, v48
    v_mul_f32 v33, v33, v49
    v_cvt_pk_bf16_f32 v62, v32, v33
    s_add_u32 m0, s30, 0
    v_mul_f32 v34, v34, v50
    buffer_load_dwordx4 v5, s[20:23], s41 offen offset:1024 lds
    v_mul_f32 v35, v35, v51
    v_cvt_pk_bf16_f32 v63, v34, v35
    v_mul_f32 v52, v8, v52
    v_mul_f32 v53, v8, v53
    v_exp_f32 v52, v52
    v_exp_f32 v53, v53
    v_mul_f32 v54, v8, v54
    s_add_u32 m0, s30, 0
    v_mul_f32 v55, v8, v55
    buffer_load_dwordx4 v5, s[20:23], s42 offen offset:2048 lds
    v_exp_f32 v54, v54
    v_exp_f32 v55, v55
    v_fmaak_f32 v52, v52, v9, 0xbf317218
    v_fmaak_f32 v53, v53, v9, 0xbf317218
    v_rcp_f32 v52, v52
    v_rcp_f32 v53, v53
    v_fmaak_f32 v54, v54, v9, 0xbf317218
    s_add_u32 m0, s30, 0
    v_fmaak_f32 v55, v55, v9, 0xbf317218
    buffer_load_dwordx4 v5, s[20:23], s43 offen offset:3072 lds
    v_rcp_f32 v54, v54
    v_rcp_f32 v55, v55
    v_mul_f32 v36, v36, v52
    v_mul_f32 v37, v37, v53
    v_cvt_pk_bf16_f32 v64, v36, v37
    v_mul_f32 v38, v38, v54
    v_mul_f32 v39, v39, v55
    v_cvt_pk_bf16_f32 v65, v38, v39
    v_mul_f32 v56, v8, v56
    v_mul_f32 v57, v8, v57
    v_exp_f32 v56, v56
    v_exp_f32 v57, v57
    v_mul_f32 v58, v8, v58
    v_mul_f32 v59, v8, v59
    v_exp_f32 v58, v58
    v_exp_f32 v59, v59
    v_fmaak_f32 v56, v56, v9, 0xbf317218
    v_fmaak_f32 v57, v57, v9, 0xbf317218
    v_rcp_f32 v56, v56
    v_rcp_f32 v57, v57
    v_fmaak_f32 v58, v58, v9, 0xbf317218
    v_fmaak_f32 v59, v59, v9, 0xbf317218
    v_rcp_f32 v58, v58
    v_rcp_f32 v59, v59
    v_mul_f32 v40, v40, v56
    v_mul_f32 v41, v41, v57
    v_cvt_pk_bf16_f32 v66, v40, v41
    v_mul_f32 v42, v42, v58
    v_mul_f32 v43, v43, v59
    v_cvt_pk_bf16_f32 v67, v42, v43
    s_waitcnt vmcnt(0)
    s_barrier
    ds_read_b128 v[16:19], v1 offset:50688
    ds_read_b128 v[20:23], v1 offset:50752
    s_waitcnt lgkmcnt(1)
    v_mfma_f32_16x16x32_bf16 v[28:31], v[16:19], v[128:131], 0
    ds_read_b128 v[24:27], v1 offset:59136
    s_waitcnt lgkmcnt(1)
    v_mfma_f32_16x16x32_bf16 v[28:31], v[20:23], v[144:147], v[28:31]
    ds_write_b128 v6, v[60:63] offset:4096
    v_mfma_f32_16x16x32_bf16 v[36:39], v[16:19], v[132:135], 0
    ds_read_b128 v[88:91], v1 offset:59200
    v_mfma_f32_16x16x32_bf16 v[36:39], v[20:23], v[148:151], v[36:39]
    v_mfma_f32_16x16x32_bf16 v[44:47], v[16:19], v[136:139], 0
    v_mfma_f32_16x16x32_bf16 v[44:47], v[20:23], v[152:155], v[44:47]
    ds_write_b128 v6, v[64:67] offset:4352
    v_mfma_f32_16x16x32_bf16 v[52:55], v[16:19], v[140:143], 0
    v_mfma_f32_16x16x32_bf16 v[52:55], v[20:23], v[156:159], v[52:55]
    s_waitcnt lgkmcnt(1)
    v_mfma_f32_16x16x32_bf16 v[32:35], v[24:27], v[128:131], 0
    ds_read_b128 v[16:19], v1 offset:50816
    v_mfma_f32_16x16x32_bf16 v[32:35], v[88:91], v[144:147], v[32:35]
    v_mfma_f32_16x16x32_bf16 v[40:43], v[24:27], v[132:135], 0
    ds_read_b128 v[20:23], v1 offset:50880
    v_mfma_f32_16x16x32_bf16 v[40:43], v[88:91], v[148:151], v[40:43]
    v_mfma_f32_16x16x32_bf16 v[48:51], v[24:27], v[136:139], 0
    v_mfma_f32_16x16x32_bf16 v[48:51], v[88:91], v[152:155], v[48:51]
    v_mfma_f32_16x16x32_bf16 v[56:59], v[24:27], v[140:143], 0
    v_mfma_f32_16x16x32_bf16 v[56:59], v[88:91], v[156:159], v[56:59]
    s_waitcnt lgkmcnt(0)
    v_mfma_f32_16x16x32_bf16 v[28:31], v[16:19], v[160:163], v[28:31]
    ds_read_b128 v[24:27], v1 offset:59264
    v_mfma_f32_16x16x32_bf16 v[28:31], v[20:23], v[176:179], v[28:31]
    ds_read_b64_tr_b16 v[128:129], v81 offset:6144
    ds_read_b64_tr_b16 v[130:131], v81 offset:6400
    v_mfma_f32_16x16x32_bf16 v[36:39], v[16:19], v[164:167], v[36:39]
    ds_read_b128 v[88:91], v1 offset:59328
    v_mfma_f32_16x16x32_bf16 v[36:39], v[20:23], v[180:183], v[36:39]
    ds_read_b64_tr_b16 v[132:133], v81 offset:6152
    ds_read_b64_tr_b16 v[134:135], v81 offset:6408
    v_mfma_f32_16x16x32_bf16 v[44:47], v[16:19], v[168:171], v[44:47]
    ds_read_b64_tr_b16 v[136:137], v81
    v_mfma_f32_16x16x32_bf16 v[44:47], v[20:23], v[184:187], v[44:47]
    ds_read_b64_tr_b16 v[138:139], v81 offset:256
    v_mfma_f32_16x16x32_bf16 v[52:55], v[16:19], v[172:175], v[52:55]
    ds_read_b64_tr_b16 v[140:141], v81 offset:8
    v_mfma_f32_16x16x32_bf16 v[52:55], v[20:23], v[188:191], v[52:55]
    s_waitcnt lgkmcnt(5)
    ds_read_b64_tr_b16 v[142:143], v81 offset:264
    v_mfma_f32_16x16x32_bf16 v[32:35], v[24:27], v[160:163], v[32:35]
    ds_read_b128 v[16:19], v1 offset:50944
    v_mfma_f32_16x16x32_bf16 v[32:35], v[88:91], v[176:179], v[32:35]
    ds_read_b64_tr_b16 v[144:145], v84
    ds_read_b64_tr_b16 v[146:147], v84 offset:256
    v_mfma_f32_16x16x32_bf16 v[40:43], v[24:27], v[164:167], v[40:43]
    ds_read_b128 v[20:23], v1 offset:51008
    v_mfma_f32_16x16x32_bf16 v[40:43], v[88:91], v[180:183], v[40:43]
    ds_read_b64_tr_b16 v[148:149], v84 offset:8
    ds_read_b64_tr_b16 v[150:151], v84 offset:264
    v_mfma_f32_16x16x32_bf16 v[48:51], v[24:27], v[168:171], v[48:51]
    ds_read_b64_tr_b16 v[152:153], v84 offset:2048
    v_mfma_f32_16x16x32_bf16 v[48:51], v[88:91], v[184:187], v[48:51]
    ds_read_b64_tr_b16 v[154:155], v84 offset:2304
    s_add_u32 m0, s29, 6144
    v_mfma_f32_16x16x32_bf16 v[56:59], v[24:27], v[172:175], v[56:59]
    ds_read_b64_tr_b16 v[156:157], v84 offset:2056
    v_mfma_f32_16x16x32_bf16 v[56:59], v[88:91], v[188:191], v[56:59]
    s_waitcnt lgkmcnt(5)
    ds_read_b64_tr_b16 v[158:159], v84 offset:2312
    buffer_load_dwordx4 v5, s[20:23], s44 offen lds
    v_mfma_f32_16x16x32_bf16 v[28:31], v[16:19], v[192:195], v[28:31]
    ds_read_b128 v[24:27], v1 offset:59392
    v_mfma_f32_16x16x32_bf16 v[28:31], v[20:23], v[208:211], v[28:31]
    v_mfma_f32_16x16x32_bf16 v[36:39], v[16:19], v[196:199], v[36:39]
    ds_read_b128 v[88:91], v1 offset:59456
    v_mfma_f32_16x16x32_bf16 v[36:39], v[20:23], v[212:215], v[36:39]
    ds_read_b128 v[160:163], v76 offset:2048
    s_add_u32 m0, s29, 6144
    v_mfma_f32_16x16x32_bf16 v[44:47], v[16:19], v[200:203], v[44:47]
    v_mfma_f32_16x16x32_bf16 v[44:47], v[20:23], v[216:219], v[44:47]
    buffer_load_dwordx4 v5, s[20:23], s45 offen offset:1024 lds
    v_mfma_f32_16x16x32_bf16 v[52:55], v[16:19], v[204:207], v[52:55]
    v_mfma_f32_16x16x32_bf16 v[52:55], v[20:23], v[220:223], v[52:55]
    s_waitcnt lgkmcnt(1)
    ds_read_b128 v[164:167], v77 offset:2048
    v_mfma_f32_16x16x32_bf16 v[32:35], v[24:27], v[192:195], v[32:35]
    ds_read_b128 v[16:19], v1 offset:51072
    v_mfma_f32_16x16x32_bf16 v[32:35], v[88:91], v[208:211], v[32:35]
    ds_read_b128 v[168:171], v78 offset:2048
    v_mfma_f32_16x16x32_bf16 v[40:43], v[24:27], v[196:199], v[40:43]
    ds_read_b128 v[20:23], v1 offset:51136
    v_mfma_f32_16x16x32_bf16 v[40:43], v[88:91], v[212:215], v[40:43]
    v_mfma_f32_16x16x32_bf16 v[48:51], v[24:27], v[200:203], v[48:51]
    ds_read_b128 v[172:175], v79 offset:2048
    v_add_u32 v14, 2654435769, v14
    v_mfma_f32_16x16x32_bf16 v[48:51], v[88:91], v[216:219], v[48:51]
    s_add_u32 s53, s33, 6291712
    buffer_load_dword v13, v7, s[4:7], s53 offen sc1
    v_mfma_f32_16x16x32_bf16 v[56:59], v[24:27], v[204:207], v[56:59]
    v_mfma_f32_16x16x32_bf16 v[56:59], v[88:91], v[220:223], v[56:59]
    s_waitcnt lgkmcnt(1)
    ds_read_b128 v[176:179], v76 offset:4096
    v_mfma_f32_16x16x32_bf16 v[28:31], v[16:19], v[224:227], v[28:31]
    ds_read_b128 v[24:27], v1 offset:59520
    v_mfma_f32_16x16x32_bf16 v[28:31], v[20:23], v[240:243], v[28:31]
    v_mfma_f32_16x16x32_bf16 v[36:39], v[16:19], v[228:231], v[36:39]
    ds_read_b128 v[88:91], v1 offset:59584
    v_mfma_f32_16x16x32_bf16 v[36:39], v[20:23], v[244:247], v[36:39]
    ds_read_b128 v[180:183], v76 offset:2304
    v_mfma_f32_16x16x32_bf16 v[44:47], v[16:19], v[232:235], v[44:47]
    v_mfma_f32_16x16x32_bf16 v[44:47], v[20:23], v[248:251], v[44:47]
    ds_read_b128 v[184:187], v77 offset:2304
    v_mfma_f32_16x16x32_bf16 v[52:55], v[16:19], v[236:239], v[52:55]
    v_mfma_f32_16x16x32_bf16 v[52:55], v[20:23], v[252:255], v[52:55]
    s_waitcnt lgkmcnt(2)
    v_mfma_f32_16x16x32_bf16 v[32:35], v[24:27], v[224:227], v[32:35]
    v_mfma_f32_16x16x32_bf16 v[32:35], v[88:91], v[240:243], v[32:35]
    ds_read_b128 v[188:191], v78 offset:2304
    v_mfma_f32_16x16x32_bf16 v[40:43], v[24:27], v[228:231], v[40:43]
    v_mfma_f32_16x16x32_bf16 v[40:43], v[88:91], v[244:247], v[40:43]
    ds_read_b128 v[192:195], v79 offset:2304
    v_mfma_f32_16x16x32_bf16 v[48:51], v[24:27], v[232:235], v[48:51]
    v_mfma_f32_16x16x32_bf16 v[48:51], v[88:91], v[248:251], v[48:51]
    ds_read_b128 v[196:199], v76 offset:4352
    v_mfma_f32_16x16x32_bf16 v[56:59], v[24:27], v[236:239], v[56:59]
    v_mfma_f32_16x16x32_bf16 v[56:59], v[88:91], v[252:255], v[56:59]
    v_mul_f32 v44, v8, v44
    s_add_u32 m0, s29, 0
    v_mul_f32 v45, v8, v45
    buffer_load_dwordx4 v5, s[20:23], s46 offen lds
    v_exp_f32 v44, v44
    v_exp_f32 v45, v45
    v_mul_f32 v46, v8, v46
    v_mul_f32 v47, v8, v47
    v_exp_f32 v46, v46
    v_exp_f32 v47, v47
    v_fmaak_f32 v44, v44, v9, 0xbf317218
    s_add_u32 m0, s29, 0
    v_fmaak_f32 v45, v45, v9, 0xbf317218
    buffer_load_dwordx4 v5, s[20:23], s47 offen offset:1024 lds
    v_rcp_f32 v44, v44
    v_rcp_f32 v45, v45
    v_fmaak_f32 v46, v46, v9, 0xbf317218
    v_fmaak_f32 v47, v47, v9, 0xbf317218
    v_rcp_f32 v46, v46
    v_rcp_f32 v47, v47
    v_mul_f32 v28, v28, v44
    s_add_u32 m0, s30, 0
    v_mul_f32 v29, v29, v45
    buffer_load_dwordx4 v5, s[20:23], s48 offen lds
    v_cvt_pk_bf16_f32 v28, v28, v29
    v_mul_f32 v30, v30, v46
    v_mul_f32 v31, v31, v47
    v_cvt_pk_bf16_f32 v29, v30, v31
    v_mul_f32 v48, v8, v48
    v_mul_f32 v49, v8, v49
    v_exp_f32 v48, v48
    s_add_u32 m0, s30, 0
    v_exp_f32 v49, v49
    buffer_load_dwordx4 v5, s[20:23], s49 offen offset:1024 lds
    v_mul_f32 v50, v8, v50
    v_mul_f32 v51, v8, v51
    v_exp_f32 v50, v50
    v_exp_f32 v51, v51
    v_fmaak_f32 v48, v48, v9, 0xbf317218
    v_fmaak_f32 v49, v49, v9, 0xbf317218
    v_rcp_f32 v48, v48
    s_add_u32 m0, s30, 0
    v_rcp_f32 v49, v49
    buffer_load_dwordx4 v5, s[20:23], s50 offen offset:2048 lds
    v_fmaak_f32 v50, v50, v9, 0xbf317218
    v_fmaak_f32 v51, v51, v9, 0xbf317218
    v_rcp_f32 v50, v50
    v_rcp_f32 v51, v51
    v_mul_f32 v32, v32, v48
    v_mul_f32 v33, v33, v49
    v_cvt_pk_bf16_f32 v30, v32, v33
    s_add_u32 m0, s30, 0
    v_mul_f32 v34, v34, v50
    buffer_load_dwordx4 v5, s[20:23], s51 offen offset:3072 lds
    v_mul_f32 v35, v35, v51
    v_cvt_pk_bf16_f32 v31, v34, v35
    s_waitcnt vmcnt(7)
    ds_read_b64_tr_b16 v[200:201], v81 offset:6144
    ds_read_b64_tr_b16 v[202:203], v81 offset:6400
    ds_read_b64_tr_b16 v[204:205], v81 offset:6152
    ds_read_b64_tr_b16 v[206:207], v81 offset:6408
    v_mul_f32 v52, v8, v52
    v_mul_f32 v53, v8, v53
    v_exp_f32 v52, v52
    v_exp_f32 v53, v53
    v_mul_f32 v54, v8, v54
    v_mul_f32 v55, v8, v55
    v_exp_f32 v54, v54
    v_exp_f32 v55, v55
    v_fmaak_f32 v52, v52, v9, 0xbf317218
    v_fmaak_f32 v53, v53, v9, 0xbf317218
    v_rcp_f32 v52, v52
    v_rcp_f32 v53, v53
    v_fmaak_f32 v54, v54, v9, 0xbf317218
    v_fmaak_f32 v55, v55, v9, 0xbf317218
    v_rcp_f32 v54, v54
    v_rcp_f32 v55, v55
    v_mul_f32 v36, v36, v52
    v_mul_f32 v37, v37, v53
    v_cvt_pk_bf16_f32 v32, v36, v37
    v_mul_f32 v38, v38, v54
    v_mul_f32 v39, v39, v55
    v_cvt_pk_bf16_f32 v33, v38, v39
    v_mul_f32 v56, v8, v56
    v_mul_f32 v57, v8, v57
    v_exp_f32 v56, v56
    v_exp_f32 v57, v57
    s_waitcnt lgkmcnt(0)
    ds_write_b128 v6, v[28:31] offset:6144
    v_mul_f32 v58, v8, v58
    v_mul_f32 v59, v8, v59
    v_exp_f32 v58, v58
    v_exp_f32 v59, v59
    v_fmaak_f32 v56, v56, v9, 0xbf317218
    v_fmaak_f32 v57, v57, v9, 0xbf317218
    v_rcp_f32 v56, v56
    v_rcp_f32 v57, v57
    v_fmaak_f32 v58, v58, v9, 0xbf317218
    v_fmaak_f32 v59, v59, v9, 0xbf317218
    v_rcp_f32 v58, v58
    v_rcp_f32 v59, v59
    v_mul_f32 v40, v40, v56
    v_mul_f32 v41, v41, v57
    v_cvt_pk_bf16_f32 v34, v40, v41
    v_mul_f32 v42, v42, v58
    v_mul_f32 v43, v43, v59
    v_cvt_pk_bf16_f32 v35, v42, v43
    ds_write_b128 v6, v[32:35] offset:6400
    s_waitcnt vmcnt(0)
    v_cmp_ne_u32 vcc, v13, v14
    s_lshl_b32 s55, s33, 2
    s_add_u32 s55, s55, 1048576
    s_cmp_lt_u32 s33, s32
    s_cselect_b32 s61, 2, 8
    s_lshl_b32 s61, s61, 10
    s_add_u32 m0, s61, s29
    s_cbranch_vccnz L_polla
    L_gota:
    s_add_u32 s54, s33, 6291456
    buffer_load_dwordx4 v11, s[4:7], s55 offen sc1 lds
    buffer_load_dwordx4 v11, s[4:7], s55 offen offset:1024 sc1 lds
    buffer_store_dword v14, v7, s[4:7], s54 offen sc1
    v_mfma_f32_4x4x4_16b_bf16 v[60:63], v[92:93], v[160:161], 0
    ds_read_b64_tr_b16 v[208:209], v81
    v_mfma_f32_4x4x4_16b_bf16 v[64:67], v[92:93], v[162:163], 0
    ds_read_b64_tr_b16 v[210:211], v81 offset:256
    v_mfma_f32_4x4x4_16b_bf16 v[68:71], v[110:111], v[180:181], 0
    ds_read_b64_tr_b16 v[212:213], v81 offset:8
    v_mfma_f32_4x4x4_16b_bf16 v[72:75], v[110:111], v[182:183], 0
    ds_read_b64_tr_b16 v[214:215], v81 offset:264
    v_mfma_f32_4x4x4_16b_bf16 v[60:63], v[94:95], v[162:163], v[60:63]
    ds_read_b64_tr_b16 v[216:217], v84
    v_mfma_f32_4x4x4_16b_bf16 v[64:67], v[94:95], v[164:165], v[64:67]
    ds_read_b64_tr_b16 v[218:219], v84 offset:256
    v_mfma_f32_4x4x4_16b_bf16 v[68:71], v[112:113], v[182:183], v[68:71]
    ds_read_b64_tr_b16 v[220:221], v84 offset:8
    v_mfma_f32_4x4x4_16b_bf16 v[72:75], v[112:113], v[184:185], v[72:75]
    ds_read_b64_tr_b16 v[222:223], v84 offset:264
    v_mfma_f32_4x4x4_16b_bf16 v[60:63], v[96:97], v[164:165], v[60:63]
    ds_read_b64_tr_b16 v[224:225], v84 offset:2048
    v_mfma_f32_4x4x4_16b_bf16 v[64:67], v[96:97], v[166:167], v[64:67]
    ds_read_b64_tr_b16 v[226:227], v84 offset:2304
    v_mfma_f32_4x4x4_16b_bf16 v[68:71], v[114:115], v[184:185], v[68:71]
    ds_read_b64_tr_b16 v[228:229], v84 offset:2056
    v_mfma_f32_4x4x4_16b_bf16 v[72:75], v[114:115], v[186:187], v[72:75]
    ds_read_b64_tr_b16 v[230:231], v84 offset:2312
    v_mfma_f32_4x4x4_16b_bf16 v[60:63], v[98:99], v[166:167], v[60:63]
    v_mfma_f32_4x4x4_16b_bf16 v[64:67], v[98:99], v[168:169], v[64:67]
    v_mfma_f32_4x4x4_16b_bf16 v[68:71], v[116:117], v[186:187], v[68:71]
    ds_read_b64_tr_b16 v[16:17], v85
    v_mfma_f32_4x4x4_16b_bf16 v[72:75], v[116:117], v[188:189], v[72:75]
    ds_read_b64_tr_b16 v[18:19], v85 offset:256
    v_mfma_f32_4x4x4_16b_bf16 v[60:63], v[100:101], v[168:169], v[60:63]
    ds_read_b64_tr_b16 v[20:21], v85 offset:2048
    v_mfma_f32_4x4x4_16b_bf16 v[64:67], v[100:101], v[170:171], v[64:67]
    ds_read_b64_tr_b16 v[22:23], v85 offset:2304
    v_mfma_f32_4x4x4_16b_bf16 v[68:71], v[118:119], v[188:189], v[68:71]
    ds_read_b64_tr_b16 v[24:25], v85 offset:4096
    v_mfma_f32_4x4x4_16b_bf16 v[72:75], v[118:119], v[190:191], v[72:75]
    ds_read_b64_tr_b16 v[26:27], v85 offset:4352
    v_mfma_f32_4x4x4_16b_bf16 v[60:63], v[102:103], v[170:171], v[60:63]
    ds_read_b64_tr_b16 v[88:89], v85 offset:6144
    v_mfma_f32_4x4x4_16b_bf16 v[64:67], v[102:103], v[172:173], v[64:67]
    ds_read_b64_tr_b16 v[90:91], v85 offset:6400
    v_mfma_f32_4x4x4_16b_bf16 v[68:71], v[120:121], v[190:191], v[68:71]
    ds_read_b64_tr_b16 v[232:233], v85 offset:8192
    v_mfma_f32_4x4x4_16b_bf16 v[72:75], v[120:121], v[192:193], v[72:75]
    ds_read_b64_tr_b16 v[234:235], v85 offset:8448
    v_mfma_f32_4x4x4_16b_bf16 v[60:63], v[104:105], v[172:173], v[60:63]
    ds_read_b64_tr_b16 v[236:237], v85 offset:10240
    v_mfma_f32_4x4x4_16b_bf16 v[64:67], v[104:105], v[174:175], v[64:67]
    ds_read_b64_tr_b16 v[238:239], v85 offset:10496
    v_mfma_f32_4x4x4_16b_bf16 v[68:71], v[122:123], v[192:193], v[68:71]
    v_mfma_f32_4x4x4_16b_bf16 v[72:75], v[122:123], v[194:195], v[72:75]
    v_mfma_f32_4x4x4_16b_bf16 v[60:63], v[106:107], v[174:175], v[60:63]
    v_mfma_f32_4x4x4_16b_bf16 v[64:67], v[106:107], v[176:177], v[64:67]
    v_mfma_f32_4x4x4_16b_bf16 v[68:71], v[124:125], v[194:195], v[68:71]
    v_mfma_f32_4x4x4_16b_bf16 v[72:75], v[124:125], v[196:197], v[72:75]
    v_mfma_f32_4x4x4_16b_bf16 v[60:63], v[108:109], v[176:177], v[60:63]
    v_mfma_f32_4x4x4_16b_bf16 v[64:67], v[108:109], v[178:179], v[64:67]
    v_mfma_f32_4x4x4_16b_bf16 v[68:71], v[126:127], v[196:197], v[68:71]
    v_mfma_f32_4x4x4_16b_bf16 v[72:75], v[126:127], v[198:199], v[72:75]
    s_waitcnt lgkmcnt(10)
    v_mfma_f32_16x16x32_bf16 v[240:243], v[128:131], v[16:19], 0
    s_waitcnt lgkmcnt(8)
    ds_read_b64_tr_b16 v[44:45], v85 offset:12288
    v_mfma_f32_16x16x32_bf16 v[240:243], v[136:139], v[20:23], v[240:243]
    ds_read_b64_tr_b16 v[46:47], v85 offset:12544
    ds_read_b128 v[160:163], v76 offset:4096
    v_mfma_f32_16x16x32_bf16 v[244:247], v[132:135], v[16:19], 0
    ds_read_b64_tr_b16 v[48:49], v85 offset:14336
    v_mfma_f32_16x16x32_bf16 v[244:247], v[140:143], v[20:23], v[244:247]
    s_waitcnt lgkmcnt(8)
    ds_read_b64_tr_b16 v[50:51], v85 offset:14592
    ds_read_b128 v[164:167], v77 offset:4096
    v_mfma_f32_16x16x32_bf16 v[240:243], v[144:147], v[24:27], v[240:243]
    ds_read_b64_tr_b16 v[16:17], v86
    v_mfma_f32_16x16x32_bf16 v[240:243], v[152:155], v[88:91], v[240:243]
    ds_read_b64_tr_b16 v[18:19], v86 offset:256
    ds_read_b128 v[168:171], v78 offset:4096
    v_mfma_f32_16x16x32_bf16 v[244:247], v[148:151], v[24:27], v[244:247]
    ds_read_b64_tr_b16 v[20:21], v86 offset:2048
    v_mfma_f32_16x16x32_bf16 v[244:247], v[156:159], v[88:91], v[244:247]
    s_waitcnt lgkmcnt(10)
    ds_read_b64_tr_b16 v[22:23], v86 offset:2304
    ds_read_b128 v[172:175], v79 offset:4096
    v_mfma_f32_16x16x32_bf16 v[240:243], v[200:203], v[232:235], v[240:243]
    ds_read_b64_tr_b16 v[24:25], v86 offset:4096
    v_mfma_f32_16x16x32_bf16 v[240:243], v[208:211], v[236:239], v[240:243]
    ds_read_b64_tr_b16 v[26:27], v86 offset:4352
    ds_read_b128 v[176:179], v76 offset:6144
    v_mfma_f32_16x16x32_bf16 v[244:247], v[204:207], v[232:235], v[244:247]
    ds_read_b64_tr_b16 v[88:89], v86 offset:6144
    v_mfma_f32_16x16x32_bf16 v[244:247], v[212:215], v[236:239], v[244:247]
    s_waitcnt lgkmcnt(11)
    ds_read_b64_tr_b16 v[90:91], v86 offset:6400
    ds_read_b128 v[180:183], v76 offset:4352
    v_mfma_f32_16x16x32_bf16 v[240:243], v[216:219], v[44:47], v[240:243]
    ds_read_b64_tr_b16 v[232:233], v86 offset:8192
    v_mfma_f32_16x16x32_bf16 v[240:243], v[224:227], v[48:51], v[240:243]
    ds_read_b64_tr_b16 v[234:235], v86 offset:8448
    ds_read_b128 v[184:187], v77 offset:4352
    v_mfma_f32_16x16x32_bf16 v[244:247], v[220:223], v[44:47], v[244:247]
    ds_read_b64_tr_b16 v[236:237], v86 offset:10240
    v_mfma_f32_16x16x32_bf16 v[244:247], v[228:231], v[48:51], v[244:247]
    s_waitcnt lgkmcnt(11)
    ds_read_b64_tr_b16 v[238:239], v86 offset:10496
    ds_read_b128 v[188:191], v78 offset:4352
    v_mfma_f32_16x16x32_bf16 v[248:251], v[128:131], v[16:19], 0
    ds_read_b64_tr_b16 v[44:45], v86 offset:12288
    v_mfma_f32_16x16x32_bf16 v[248:251], v[136:139], v[20:23], v[248:251]
    ds_read_b64_tr_b16 v[46:47], v86 offset:12544
    ds_read_b128 v[192:195], v79 offset:4352
    v_mfma_f32_16x16x32_bf16 v[252:255], v[132:135], v[16:19], 0
    ds_read_b64_tr_b16 v[48:49], v86 offset:14336
    v_mfma_f32_16x16x32_bf16 v[252:255], v[140:143], v[20:23], v[252:255]
    s_waitcnt lgkmcnt(11)
    ds_read_b64_tr_b16 v[50:51], v86 offset:14592
    ds_read_b128 v[196:199], v76 offset:6400
    v_mfma_f32_16x16x32_bf16 v[248:251], v[144:147], v[24:27], v[248:251]
    v_mfma_f32_16x16x32_bf16 v[248:251], v[152:155], v[88:91], v[248:251]
    v_mfma_f32_16x16x32_bf16 v[252:255], v[148:151], v[24:27], v[252:255]
    v_mfma_f32_16x16x32_bf16 v[252:255], v[156:159], v[88:91], v[252:255]
    s_waitcnt lgkmcnt(7)
    v_mfma_f32_16x16x32_bf16 v[248:251], v[200:203], v[232:235], v[248:251]
    v_mfma_f32_16x16x32_bf16 v[248:251], v[208:211], v[236:239], v[248:251]
    v_mfma_f32_16x16x32_bf16 v[252:255], v[204:207], v[232:235], v[252:255]
    v_mfma_f32_16x16x32_bf16 v[252:255], v[212:215], v[236:239], v[252:255]
    s_waitcnt lgkmcnt(4)
    v_mfma_f32_16x16x32_bf16 v[248:251], v[216:219], v[44:47], v[248:251]
    s_waitcnt lgkmcnt(1)
    v_mfma_f32_16x16x32_bf16 v[248:251], v[224:227], v[48:51], v[248:251]
    v_mfma_f32_16x16x32_bf16 v[252:255], v[220:223], v[44:47], v[252:255]
    v_mfma_f32_16x16x32_bf16 v[252:255], v[228:231], v[48:51], v[252:255]
    s_barrier
    v_cvt_pk_bf16_f32 v28, v240, v241
    v_cvt_pk_bf16_f32 v29, v242, v243
    v_cvt_pk_bf16_f32 v30, v244, v245
    v_cvt_pk_bf16_f32 v31, v246, v247
    ds_write_b128 v82, v[28:31] offset:50688
    v_cvt_pk_bf16_f32 v32, v248, v249
    v_cvt_pk_bf16_f32 v33, v250, v251
    v_cvt_pk_bf16_f32 v34, v252, v253
    v_cvt_pk_bf16_f32 v35, v254, v255
    ds_write_b128 v82, v[32:35] offset:51712
    v_exp_f32 v0, v60
    v_exp_f32 v15, v61
    v_fmaak_f32 v0, v0, v8, 0xbfb8aa3b
    v_fmaak_f32 v15, v15, v8, 0xbfb8aa3b
    v_rcp_f32 v0, v0
    v_rcp_f32 v15, v15
    ds_read_b128 v[36:39], v83 offset:50688
    ds_read_b128 v[40:43], v83 offset:51712
    v_mul_f32 v60, v60, v0
    v_mul_f32 v61, v61, v15
    v_exp_f32 v87, v62
    v_exp_f32 v4, v63
    v_fmaak_f32 v87, v87, v8, 0xbfb8aa3b
    v_fmaak_f32 v4, v4, v8, 0xbfb8aa3b
    v_rcp_f32 v87, v87
    v_rcp_f32 v4, v4
    v_mul_f32 v62, v62, v87
    v_mul_f32 v63, v63, v4
    v_exp_f32 v0, v64
    v_exp_f32 v15, v65
    s_add_u32 s53, s52, 8192
    s_waitcnt lgkmcnt(1)
    buffer_store_dwordx4 v[36:39], v5, s[24:27], s53 offen sc0 sc1
    v_fmaak_f32 v0, v0, v8, 0xbfb8aa3b
    v_fmaak_f32 v15, v15, v8, 0xbfb8aa3b
    v_rcp_f32 v0, v0
    v_rcp_f32 v15, v15
    v_mul_f32 v64, v64, v0
    v_mul_f32 v65, v65, v15
    v_exp_f32 v87, v66
    v_exp_f32 v4, v67
    v_fmaak_f32 v87, v87, v8, 0xbfb8aa3b
    v_fmaak_f32 v4, v4, v8, 0xbfb8aa3b
    v_rcp_f32 v87, v87
    v_rcp_f32 v4, v4
    s_add_u32 s53, s52, 16384
    s_waitcnt lgkmcnt(0)
    buffer_store_dwordx4 v[40:43], v5, s[24:27], s53 offen sc0 sc1
    v_mul_f32 v66, v66, v87
    v_mul_f32 v67, v67, v4
    v_cvt_pk_bf16_f32 v60, v60, v61
    v_cvt_pk_bf16_f32 v61, v62, v63
    v_cvt_pk_bf16_f32 v62, v64, v65
    v_cvt_pk_bf16_f32 v63, v66, v67
    v_exp_f32 v0, v68
    v_exp_f32 v15, v69
    v_fmaak_f32 v0, v0, v8, 0xbfb8aa3b
    v_fmaak_f32 v15, v15, v8, 0xbfb8aa3b
    v_rcp_f32 v0, v0
    v_rcp_f32 v15, v15
    v_mul_f32 v68, v68, v0
    v_mul_f32 v69, v69, v15
    v_exp_f32 v87, v70
    v_exp_f32 v4, v71
    v_fmaak_f32 v87, v87, v8, 0xbfb8aa3b
    v_fmaak_f32 v4, v4, v8, 0xbfb8aa3b
    v_rcp_f32 v87, v87
    v_rcp_f32 v4, v4
    v_mul_f32 v70, v70, v87
    v_mul_f32 v71, v71, v4
    v_exp_f32 v0, v72
    v_exp_f32 v15, v73
    v_fmaak_f32 v0, v0, v8, 0xbfb8aa3b
    v_fmaak_f32 v15, v15, v8, 0xbfb8aa3b
    v_rcp_f32 v0, v0
    v_rcp_f32 v15, v15
    v_mul_f32 v72, v72, v0
    v_mul_f32 v73, v73, v15
    v_exp_f32 v87, v74
    v_exp_f32 v4, v75
    v_fmaak_f32 v87, v87, v8, 0xbfb8aa3b
    v_fmaak_f32 v4, v4, v8, 0xbfb8aa3b
    v_rcp_f32 v87, v87
    v_rcp_f32 v4, v4
    v_mul_f32 v74, v74, v87
    v_mul_f32 v75, v75, v4
    v_cvt_pk_bf16_f32 v68, v68, v69
    v_cvt_pk_bf16_f32 v69, v70, v71
    v_cvt_pk_bf16_f32 v70, v72, v73
    v_cvt_pk_bf16_f32 v71, v74, v75
    ds_write_b128 v80, v[60:63] offset:16896
    ds_write_b128 v80, v[68:71] offset:17920
    v_mfma_f32_4x4x4_16b_bf16 v[60:63], v[92:93], v[160:161], 0
    v_mfma_f32_4x4x4_16b_bf16 v[64:67], v[92:93], v[162:163], 0
    v_mfma_f32_4x4x4_16b_bf16 v[68:71], v[110:111], v[180:181], 0
    v_mfma_f32_4x4x4_16b_bf16 v[72:75], v[110:111], v[182:183], 0
    v_mfma_f32_4x4x4_16b_bf16 v[60:63], v[94:95], v[162:163], v[60:63]
    v_mfma_f32_4x4x4_16b_bf16 v[64:67], v[94:95], v[164:165], v[64:67]
    v_mfma_f32_4x4x4_16b_bf16 v[68:71], v[112:113], v[182:183], v[68:71]
    v_mfma_f32_4x4x4_16b_bf16 v[72:75], v[112:113], v[184:185], v[72:75]
    v_mfma_f32_4x4x4_16b_bf16 v[60:63], v[96:97], v[164:165], v[60:63]
    v_mfma_f32_4x4x4_16b_bf16 v[64:67], v[96:97], v[166:167], v[64:67]
    v_mfma_f32_4x4x4_16b_bf16 v[68:71], v[114:115], v[184:185], v[68:71]
    v_mfma_f32_4x4x4_16b_bf16 v[72:75], v[114:115], v[186:187], v[72:75]
    v_mfma_f32_4x4x4_16b_bf16 v[60:63], v[98:99], v[166:167], v[60:63]
    v_mfma_f32_4x4x4_16b_bf16 v[64:67], v[98:99], v[168:169], v[64:67]
    v_mfma_f32_4x4x4_16b_bf16 v[68:71], v[116:117], v[186:187], v[68:71]
    v_mfma_f32_4x4x4_16b_bf16 v[72:75], v[116:117], v[188:189], v[72:75]
    v_mfma_f32_4x4x4_16b_bf16 v[60:63], v[100:101], v[168:169], v[60:63]
    v_mfma_f32_4x4x4_16b_bf16 v[64:67], v[100:101], v[170:171], v[64:67]
    v_mfma_f32_4x4x4_16b_bf16 v[68:71], v[118:119], v[188:189], v[68:71]
    v_mfma_f32_4x4x4_16b_bf16 v[72:75], v[118:119], v[190:191], v[72:75]
    v_mfma_f32_4x4x4_16b_bf16 v[60:63], v[102:103], v[170:171], v[60:63]
    v_mfma_f32_4x4x4_16b_bf16 v[64:67], v[102:103], v[172:173], v[64:67]
    v_mfma_f32_4x4x4_16b_bf16 v[68:71], v[120:121], v[190:191], v[68:71]
    v_mfma_f32_4x4x4_16b_bf16 v[72:75], v[120:121], v[192:193], v[72:75]
    v_mfma_f32_4x4x4_16b_bf16 v[60:63], v[104:105], v[172:173], v[60:63]
    v_mfma_f32_4x4x4_16b_bf16 v[64:67], v[104:105], v[174:175], v[64:67]
    v_mfma_f32_4x4x4_16b_bf16 v[68:71], v[122:123], v[192:193], v[68:71]
    v_mfma_f32_4x4x4_16b_bf16 v[72:75], v[122:123], v[194:195], v[72:75]
    v_mfma_f32_4x4x4_16b_bf16 v[60:63], v[106:107], v[174:175], v[60:63]
    v_mfma_f32_4x4x4_16b_bf16 v[64:67], v[106:107], v[176:177], v[64:67]
    v_mfma_f32_4x4x4_16b_bf16 v[68:71], v[124:125], v[194:195], v[68:71]
    v_mfma_f32_4x4x4_16b_bf16 v[72:75], v[124:125], v[196:197], v[72:75]
    v_mfma_f32_4x4x4_16b_bf16 v[60:63], v[108:109], v[176:177], v[60:63]
    v_mfma_f32_4x4x4_16b_bf16 v[64:67], v[108:109], v[178:179], v[64:67]
    v_mfma_f32_4x4x4_16b_bf16 v[68:71], v[126:127], v[196:197], v[68:71]
    v_mfma_f32_4x4x4_16b_bf16 v[72:75], v[126:127], v[198:199], v[72:75]
    s_cmp_lt_u32 s33, s32
    s_cbranch_scc0 L_lreta
    v_mov_b32 v12, 0
    v_lshlrev_b32 v15, 4, v10
    v_sub_u32 v15, 8192, v15
    v_add_u32 v0, v15, v6
    ds_write_b32 v0, v12
    ds_write_b32 v0, v12 offset:4
    ds_write_b32 v0, v12 offset:8
    ds_write_b32 v0, v12 offset:12
    ds_write_b32 v0, v12 offset:256
    ds_write_b32 v0, v12 offset:260
    ds_write_b32 v0, v12 offset:264
    ds_write_b32 v0, v12 offset:268
    v_bfe_i32 v87, v11, 5, 1
    v_and_b32 v87, 6144, v87
    v_sub_u32 v76, v76, v87
    v_sub_u32 v77, v77, v87
    v_sub_u32 v78, v78, v87
    v_sub_u32 v79, v79, v87
    s_waitcnt lgkmcnt(0)
    L_lreta:
    s_waitcnt vmcnt(3)
    v_exp_f32 v0, v60
    v_exp_f32 v15, v61
    v_fmaak_f32 v0, v0, v8, 0xbfb8aa3b
    v_fmaak_f32 v15, v15, v8, 0xbfb8aa3b
    L_pad2:
    s_cbranch_execz L_ret0
    v_rcp_f32 v0, v0
    v_rcp_f32 v15, v15
    ds_read_b128 v[160:163], v76 offset:6144
    ds_read_b128 v[164:167], v77 offset:6144
    v_mul_f32 v60, v60, v0
    v_mul_f32 v61, v61, v15
    v_exp_f32 v87, v62
    v_exp_f32 v4, v63
    v_fmaak_f32 v87, v87, v8, 0xbfb8aa3b
    v_fmaak_f32 v4, v4, v8, 0xbfb8aa3b
    v_rcp_f32 v87, v87
    v_rcp_f32 v4, v4
    s_waitcnt lgkmcnt(2)
    s_barrier
    v_mul_f32 v62, v62, v87
    v_mul_f32 v63, v63, v4
    v_exp_f32 v0, v64
    v_exp_f32 v15, v65
    ds_read_b128 v[168:171], v78 offset:6144
    ds_read_b128 v[172:175], v79 offset:6144
    v_fmaak_f32 v0, v0, v8, 0xbfb8aa3b
    v_fmaak_f32 v15, v15, v8, 0xbfb8aa3b
    v_rcp_f32 v0, v0
    v_rcp_f32 v15, v15
    v_mul_f32 v64, v64, v0
    v_mul_f32 v65, v65, v15
    v_exp_f32 v87, v66
    v_exp_f32 v4, v67
    v_fmaak_f32 v87, v87, v8, 0xbfb8aa3b
    v_fmaak_f32 v4, v4, v8, 0xbfb8aa3b
    v_rcp_f32 v87, v87
    v_rcp_f32 v4, v4
    ds_read_b128 v[176:179], v76 offset:8192
    ds_read_b128 v[180:183], v76 offset:6400
    v_mul_f32 v66, v66, v87
    v_mul_f32 v67, v67, v4
    v_cvt_pk_bf16_f32 v60, v60, v61
    v_cvt_pk_bf16_f32 v61, v62, v63
    v_cvt_pk_bf16_f32 v62, v64, v65
    v_cvt_pk_bf16_f32 v63, v66, v67
    v_exp_f32 v0, v68
    v_exp_f32 v15, v69
    v_fmaak_f32 v0, v0, v8, 0xbfb8aa3b
    v_fmaak_f32 v15, v15, v8, 0xbfb8aa3b
    v_rcp_f32 v0, v0
    v_rcp_f32 v15, v15
    ds_read_b128 v[184:187], v77 offset:6400
    ds_read_b128 v[188:191], v78 offset:6400
    v_mul_f32 v68, v68, v0
    v_mul_f32 v69, v69, v15
    v_exp_f32 v87, v70
    v_exp_f32 v4, v71
    v_fmaak_f32 v87, v87, v8, 0xbfb8aa3b
    v_fmaak_f32 v4, v4, v8, 0xbfb8aa3b
    v_rcp_f32 v87, v87
    v_rcp_f32 v4, v4
    v_mul_f32 v70, v70, v87
    v_mul_f32 v71, v71, v4
    v_exp_f32 v0, v72
    v_exp_f32 v15, v73
    ds_read_b128 v[192:195], v79 offset:6400
    ds_read_b128 v[196:199], v76 offset:8448
    v_fmaak_f32 v0, v0, v8, 0xbfb8aa3b
    v_fmaak_f32 v15, v15, v8, 0xbfb8aa3b
    v_rcp_f32 v0, v0
    v_rcp_f32 v15, v15
    v_mul_f32 v72, v72, v0
    v_mul_f32 v73, v73, v15
    v_exp_f32 v87, v74
    v_exp_f32 v4, v75
    v_fmaak_f32 v87, v87, v8, 0xbfb8aa3b
    v_fmaak_f32 v4, v4, v8, 0xbfb8aa3b
    v_rcp_f32 v87, v87
    v_rcp_f32 v4, v4
    v_mul_f32 v74, v74, v87
    v_mul_f32 v75, v75, v4
    v_cvt_pk_bf16_f32 v68, v68, v69
    v_cvt_pk_bf16_f32 v69, v70, v71
    v_cvt_pk_bf16_f32 v70, v72, v73
    v_cvt_pk_bf16_f32 v71, v74, v75
    ds_read_b64_tr_b16 v[16:17], v85 offset:16896
    ds_read_b64_tr_b16 v[18:19], v85 offset:17152
    ds_read_b64_tr_b16 v[20:21], v85 offset:18944
    ds_read_b64_tr_b16 v[22:23], v85 offset:19200
    ds_read_b64_tr_b16 v[24:25], v85 offset:20992
    ds_read_b64_tr_b16 v[26:27], v85 offset:21248
    ds_read_b64_tr_b16 v[88:89], v85 offset:23040
    ds_read_b64_tr_b16 v[90:91], v85 offset:23296
    s_waitcnt lgkmcnt(6)
    v_mfma_f32_16x16x32_bf16 v[240:243], v[128:131], v[16:19], 0
    s_waitcnt lgkmcnt(4)
    ds_read_b64_tr_b16 v[232:233], v85 offset:25088
    v_mfma_f32_16x16x32_bf16 v[240:243], v[136:139], v[20:23], v[240:243]
    ds_read_b64_tr_b16 v[234:235], v85 offset:25344
    v_mfma_f32_16x16x32_bf16 v[244:247], v[132:135], v[16:19], 0
    ds_read_b64_tr_b16 v[236:237], v85 offset:27136
    v_mfma_f32_16x16x32_bf16 v[244:247], v[140:143], v[20:23], v[244:247]
    s_waitcnt lgkmcnt(3)
    ds_read_b64_tr_b16 v[238:239], v85 offset:27392
    v_mfma_f32_16x16x32_bf16 v[240:243], v[144:147], v[24:27], v[240:243]
    ds_read_b64_tr_b16 v[44:45], v85 offset:29184
    v_mfma_f32_16x16x32_bf16 v[240:243], v[152:155], v[88:91], v[240:243]
    ds_read_b64_tr_b16 v[46:47], v85 offset:29440
    v_mfma_f32_16x16x32_bf16 v[244:247], v[148:151], v[24:27], v[244:247]
    ds_read_b64_tr_b16 v[48:49], v85 offset:31232
    v_mfma_f32_16x16x32_bf16 v[244:247], v[156:159], v[88:91], v[244:247]
    s_waitcnt lgkmcnt(3)
    ds_read_b64_tr_b16 v[50:51], v85 offset:31488
    v_mfma_f32_16x16x32_bf16 v[240:243], v[200:203], v[232:235], v[240:243]
    ds_read_b64_tr_b16 v[16:17], v86 offset:16896
    v_mfma_f32_16x16x32_bf16 v[240:243], v[208:211], v[236:239], v[240:243]
    ds_read_b64_tr_b16 v[18:19], v86 offset:17152
    v_mfma_f32_16x16x32_bf16 v[244:247], v[204:207], v[232:235], v[244:247]
    ds_read_b64_tr_b16 v[20:21], v86 offset:18944
    v_mfma_f32_16x16x32_bf16 v[244:247], v[212:215], v[236:239], v[244:247]
    s_waitcnt lgkmcnt(3)
    ds_read_b64_tr_b16 v[22:23], v86 offset:19200
    v_mfma_f32_16x16x32_bf16 v[240:243], v[216:219], v[44:47], v[240:243]
    ds_read_b64_tr_b16 v[24:25], v86 offset:20992
    v_mfma_f32_16x16x32_bf16 v[240:243], v[224:227], v[48:51], v[240:243]
    ds_read_b64_tr_b16 v[26:27], v86 offset:21248
    v_mfma_f32_16x16x32_bf16 v[244:247], v[220:223], v[44:47], v[244:247]
    ds_read_b64_tr_b16 v[88:89], v86 offset:23040
    v_mfma_f32_16x16x32_bf16 v[244:247], v[228:231], v[48:51], v[244:247]
    s_waitcnt lgkmcnt(3)
    ds_read_b64_tr_b16 v[90:91], v86 offset:23296
    v_mfma_f32_16x16x32_bf16 v[248:251], v[128:131], v[16:19], 0
    ds_read_b64_tr_b16 v[232:233], v86 offset:25088
    v_mfma_f32_16x16x32_bf16 v[248:251], v[136:139], v[20:23], v[248:251]
    ds_read_b64_tr_b16 v[234:235], v86 offset:25344
    v_mfma_f32_16x16x32_bf16 v[252:255], v[132:135], v[16:19], 0
    ds_read_b64_tr_b16 v[236:237], v86 offset:27136
    v_mfma_f32_16x16x32_bf16 v[252:255], v[140:143], v[20:23], v[252:255]
    s_waitcnt lgkmcnt(3)
    ds_read_b64_tr_b16 v[238:239], v86 offset:27392
    v_mfma_f32_16x16x32_bf16 v[248:251], v[144:147], v[24:27], v[248:251]
    ds_read_b64_tr_b16 v[44:45], v86 offset:29184
    v_mfma_f32_16x16x32_bf16 v[248:251], v[152:155], v[88:91], v[248:251]
    ds_read_b64_tr_b16 v[46:47], v86 offset:29440
    v_mfma_f32_16x16x32_bf16 v[252:255], v[148:151], v[24:27], v[252:255]
    ds_read_b64_tr_b16 v[48:49], v86 offset:31232
    v_mfma_f32_16x16x32_bf16 v[252:255], v[156:159], v[88:91], v[252:255]
    s_waitcnt lgkmcnt(3)
    ds_read_b64_tr_b16 v[50:51], v86 offset:31488
    v_mfma_f32_16x16x32_bf16 v[248:251], v[200:203], v[232:235], v[248:251]
    v_mfma_f32_16x16x32_bf16 v[248:251], v[208:211], v[236:239], v[248:251]
    ds_write_b128 v80, v[60:63]
    v_mfma_f32_16x16x32_bf16 v[252:255], v[204:207], v[232:235], v[252:255]
    v_mfma_f32_16x16x32_bf16 v[252:255], v[212:215], v[236:239], v[252:255]
    s_waitcnt lgkmcnt(3)
    v_mfma_f32_16x16x32_bf16 v[248:251], v[216:219], v[44:47], v[248:251]
    s_waitcnt lgkmcnt(1)
    v_mfma_f32_16x16x32_bf16 v[248:251], v[224:227], v[48:51], v[248:251]
    ds_write_b128 v80, v[68:71] offset:1024
    v_mfma_f32_16x16x32_bf16 v[252:255], v[220:223], v[44:47], v[252:255]
    v_mfma_f32_16x16x32_bf16 v[252:255], v[228:231], v[48:51], v[252:255]
    v_mfma_f32_4x4x4_16b_bf16 v[60:63], v[92:93], v[160:161], 0
    v_mfma_f32_4x4x4_16b_bf16 v[64:67], v[92:93], v[162:163], 0
    v_mfma_f32_4x4x4_16b_bf16 v[68:71], v[110:111], v[180:181], 0
    v_mfma_f32_4x4x4_16b_bf16 v[72:75], v[110:111], v[182:183], 0
    v_mfma_f32_4x4x4_16b_bf16 v[60:63], v[94:95], v[162:163], v[60:63]
    v_mfma_f32_4x4x4_16b_bf16 v[64:67], v[94:95], v[164:165], v[64:67]
    v_mfma_f32_4x4x4_16b_bf16 v[68:71], v[112:113], v[182:183], v[68:71]
    v_mfma_f32_4x4x4_16b_bf16 v[72:75], v[112:113], v[184:185], v[72:75]
    v_mfma_f32_4x4x4_16b_bf16 v[60:63], v[96:97], v[164:165], v[60:63]
    v_mfma_f32_4x4x4_16b_bf16 v[64:67], v[96:97], v[166:167], v[64:67]
    v_mfma_f32_4x4x4_16b_bf16 v[68:71], v[114:115], v[184:185], v[68:71]
    v_mfma_f32_4x4x4_16b_bf16 v[72:75], v[114:115], v[186:187], v[72:75]
    v_mfma_f32_4x4x4_16b_bf16 v[60:63], v[98:99], v[166:167], v[60:63]
    v_mfma_f32_4x4x4_16b_bf16 v[64:67], v[98:99], v[168:169], v[64:67]
    v_mfma_f32_4x4x4_16b_bf16 v[68:71], v[116:117], v[186:187], v[68:71]
    v_mfma_f32_4x4x4_16b_bf16 v[72:75], v[116:117], v[188:189], v[72:75]
    v_mfma_f32_4x4x4_16b_bf16 v[60:63], v[100:101], v[168:169], v[60:63]
    v_mfma_f32_4x4x4_16b_bf16 v[64:67], v[100:101], v[170:171], v[64:67]
    v_mfma_f32_4x4x4_16b_bf16 v[68:71], v[118:119], v[188:189], v[68:71]
    v_mfma_f32_4x4x4_16b_bf16 v[72:75], v[118:119], v[190:191], v[72:75]
    v_mfma_f32_4x4x4_16b_bf16 v[60:63], v[102:103], v[170:171], v[60:63]
    v_mfma_f32_4x4x4_16b_bf16 v[64:67], v[102:103], v[172:173], v[64:67]
    v_mfma_f32_4x4x4_16b_bf16 v[68:71], v[120:121], v[190:191], v[68:71]
    v_mfma_f32_4x4x4_16b_bf16 v[72:75], v[120:121], v[192:193], v[72:75]
    v_mfma_f32_4x4x4_16b_bf16 v[60:63], v[104:105], v[172:173], v[60:63]
    v_mfma_f32_4x4x4_16b_bf16 v[64:67], v[104:105], v[174:175], v[64:67]
    v_mfma_f32_4x4x4_16b_bf16 v[68:71], v[122:123], v[192:193], v[68:71]
    v_mfma_f32_4x4x4_16b_bf16 v[72:75], v[122:123], v[194:195], v[72:75]
    v_mfma_f32_4x4x4_16b_bf16 v[60:63], v[106:107], v[174:175], v[60:63]
    v_mfma_f32_4x4x4_16b_bf16 v[64:67], v[106:107], v[176:177], v[64:67]
    v_mfma_f32_4x4x4_16b_bf16 v[68:71], v[124:125], v[194:195], v[68:71]
    v_mfma_f32_4x4x4_16b_bf16 v[72:75], v[124:125], v[196:197], v[72:75]
    v_mfma_f32_4x4x4_16b_bf16 v[60:63], v[108:109], v[176:177], v[60:63]
    v_mfma_f32_4x4x4_16b_bf16 v[64:67], v[108:109], v[178:179], v[64:67]
    v_mfma_f32_4x4x4_16b_bf16 v[68:71], v[126:127], v[196:197], v[68:71]
    v_mfma_f32_4x4x4_16b_bf16 v[72:75], v[126:127], v[198:199], v[72:75]
    s_setprio 3
    v_cvt_pk_bf16_f32 v28, v240, v241
    v_cvt_pk_bf16_f32 v29, v242, v243
    v_cvt_pk_bf16_f32 v30, v244, v245
    v_cvt_pk_bf16_f32 v31, v246, v247
    ds_write_b128 v82, v[28:31] offset:50688
    v_cvt_pk_bf16_f32 v32, v248, v249
    v_cvt_pk_bf16_f32 v33, v250, v251
    v_cvt_pk_bf16_f32 v34, v252, v253
    v_cvt_pk_bf16_f32 v35, v254, v255
    ds_write_b128 v82, v[32:35] offset:51712
    v_exp_f32 v0, v60
    v_exp_f32 v15, v61
    v_fmaak_f32 v0, v0, v8, 0xbfb8aa3b
    v_fmaak_f32 v15, v15, v8, 0xbfb8aa3b
    v_rcp_f32 v0, v0
    v_rcp_f32 v15, v15
    s_waitcnt lgkmcnt(2)
    s_barrier
    ds_read_b128 v[36:39], v83 offset:50688
    ds_read_b128 v[40:43], v83 offset:51712
    v_mul_f32 v60, v60, v0
    v_mul_f32 v61, v61, v15
    v_exp_f32 v87, v62
    v_exp_f32 v4, v63
    v_fmaak_f32 v87, v87, v8, 0xbfb8aa3b
    v_fmaak_f32 v4, v4, v8, 0xbfb8aa3b
    v_rcp_f32 v87, v87
    v_rcp_f32 v4, v4
    v_mul_f32 v62, v62, v87
    v_mul_f32 v63, v63, v4
    v_exp_f32 v0, v64
    v_exp_f32 v15, v65
    s_add_u32 s53, s52, 24576
    s_waitcnt lgkmcnt(1)
    buffer_store_dwordx4 v[36:39], v5, s[24:27], s53 offen sc0 sc1
    v_fmaak_f32 v0, v0, v8, 0xbfb8aa3b
    v_fmaak_f32 v15, v15, v8, 0xbfb8aa3b
    v_rcp_f32 v0, v0
    v_rcp_f32 v15, v15
    v_mul_f32 v64, v64, v0
    v_mul_f32 v65, v65, v15
    v_exp_f32 v87, v66
    v_exp_f32 v4, v67
    v_fmaak_f32 v87, v87, v8, 0xbfb8aa3b
    v_fmaak_f32 v4, v4, v8, 0xbfb8aa3b
    v_rcp_f32 v87, v87
    v_rcp_f32 v4, v4
    s_add_u32 s53, s52, 32768
    s_waitcnt lgkmcnt(0)
    buffer_store_dwordx4 v[40:43], v5, s[24:27], s53 offen sc0 sc1
    v_mul_f32 v66, v66, v87
    v_mul_f32 v67, v67, v4
    v_cvt_pk_bf16_f32 v60, v60, v61
    v_cvt_pk_bf16_f32 v61, v62, v63
    v_cvt_pk_bf16_f32 v62, v64, v65
    v_cvt_pk_bf16_f32 v63, v66, v67
    v_exp_f32 v0, v68
    v_exp_f32 v15, v69
    v_fmaak_f32 v0, v0, v8, 0xbfb8aa3b
    v_fmaak_f32 v15, v15, v8, 0xbfb8aa3b
    v_rcp_f32 v0, v0
    v_rcp_f32 v15, v15
    v_mul_f32 v68, v68, v0
    v_mul_f32 v69, v69, v15
    v_exp_f32 v87, v70
    v_exp_f32 v4, v71
    v_fmaak_f32 v87, v87, v8, 0xbfb8aa3b
    v_fmaak_f32 v4, v4, v8, 0xbfb8aa3b
    v_rcp_f32 v87, v87
    v_rcp_f32 v4, v4
    v_mul_f32 v70, v70, v87
    v_mul_f32 v71, v71, v4
    v_exp_f32 v0, v72
    v_exp_f32 v15, v73
    v_fmaak_f32 v0, v0, v8, 0xbfb8aa3b
    v_fmaak_f32 v15, v15, v8, 0xbfb8aa3b
    v_rcp_f32 v0, v0
    v_rcp_f32 v15, v15
    v_mul_f32 v72, v72, v0
    v_mul_f32 v73, v73, v15
    v_exp_f32 v87, v74
    v_exp_f32 v4, v75
    v_fmaak_f32 v87, v87, v8, 0xbfb8aa3b
    v_fmaak_f32 v4, v4, v8, 0xbfb8aa3b
    v_rcp_f32 v87, v87
    v_rcp_f32 v4, v4
    v_mul_f32 v74, v74, v87
    v_mul_f32 v75, v75, v4
    v_cvt_pk_bf16_f32 v68, v68, v69
    v_cvt_pk_bf16_f32 v69, v70, v71
    v_cvt_pk_bf16_f32 v70, v72, v73
    v_cvt_pk_bf16_f32 v71, v74, v75
    ds_read_b64_tr_b16 v[16:17], v85
    ds_read_b64_tr_b16 v[18:19], v85 offset:256
    ds_read_b64_tr_b16 v[20:21], v85 offset:2048
    ds_read_b64_tr_b16 v[22:23], v85 offset:2304
    ds_read_b64_tr_b16 v[24:25], v85 offset:4096
    ds_read_b64_tr_b16 v[26:27], v85 offset:4352
    ds_read_b64_tr_b16 v[88:89], v85 offset:6144
    ds_read_b64_tr_b16 v[90:91], v85 offset:6400
    s_setprio 0
    s_waitcnt lgkmcnt(6)
    v_mfma_f32_16x16x32_bf16 v[240:243], v[128:131], v[16:19], 0
    s_waitcnt lgkmcnt(4)
    ds_read_b64_tr_b16 v[232:233], v85 offset:8192
    v_mfma_f32_16x16x32_bf16 v[240:243], v[136:139], v[20:23], v[240:243]
    ds_read_b64_tr_b16 v[234:235], v85 offset:8448
    v_mfma_f32_16x16x32_bf16 v[244:247], v[132:135], v[16:19], 0
    ds_read_b64_tr_b16 v[236:237], v85 offset:10240
    v_mfma_f32_16x16x32_bf16 v[244:247], v[140:143], v[20:23], v[244:247]
    s_waitcnt lgkmcnt(3)
    ds_read_b64_tr_b16 v[238:239], v85 offset:10496
    v_mfma_f32_16x16x32_bf16 v[240:243], v[144:147], v[24:27], v[240:243]
    ds_read_b64_tr_b16 v[44:45], v85 offset:12288
    v_mfma_f32_16x16x32_bf16 v[240:243], v[152:155], v[88:91], v[240:243]
    ds_read_b64_tr_b16 v[46:47], v85 offset:12544
    v_mfma_f32_16x16x32_bf16 v[244:247], v[148:151], v[24:27], v[244:247]
    ds_read_b64_tr_b16 v[48:49], v85 offset:14336
    v_mfma_f32_16x16x32_bf16 v[244:247], v[156:159], v[88:91], v[244:247]
    s_waitcnt lgkmcnt(3)
    ds_read_b64_tr_b16 v[50:51], v85 offset:14592
    v_mfma_f32_16x16x32_bf16 v[240:243], v[200:203], v[232:235], v[240:243]
    ds_read_b64_tr_b16 v[16:17], v86
    v_mfma_f32_16x16x32_bf16 v[240:243], v[208:211], v[236:239], v[240:243]
    ds_read_b64_tr_b16 v[18:19], v86 offset:256
    v_mfma_f32_16x16x32_bf16 v[244:247], v[204:207], v[232:235], v[244:247]
    ds_read_b64_tr_b16 v[20:21], v86 offset:2048
    v_mfma_f32_16x16x32_bf16 v[244:247], v[212:215], v[236:239], v[244:247]
    s_waitcnt lgkmcnt(3)
    ds_read_b64_tr_b16 v[22:23], v86 offset:2304
    v_mfma_f32_16x16x32_bf16 v[240:243], v[216:219], v[44:47], v[240:243]
    ds_read_b64_tr_b16 v[24:25], v86 offset:4096
    v_mfma_f32_16x16x32_bf16 v[240:243], v[224:227], v[48:51], v[240:243]
    ds_read_b64_tr_b16 v[26:27], v86 offset:4352
    v_mfma_f32_16x16x32_bf16 v[244:247], v[220:223], v[44:47], v[244:247]
    ds_read_b64_tr_b16 v[88:89], v86 offset:6144
    v_mfma_f32_16x16x32_bf16 v[244:247], v[228:231], v[48:51], v[244:247]
    s_waitcnt lgkmcnt(3)
    ds_read_b64_tr_b16 v[90:91], v86 offset:6400
    v_mfma_f32_16x16x32_bf16 v[248:251], v[128:131], v[16:19], 0
    ds_read_b64_tr_b16 v[232:233], v86 offset:8192
    v_mfma_f32_16x16x32_bf16 v[248:251], v[136:139], v[20:23], v[248:251]
    ds_read_b64_tr_b16 v[234:235], v86 offset:8448
    v_mfma_f32_16x16x32_bf16 v[252:255], v[132:135], v[16:19], 0
    ds_read_b64_tr_b16 v[236:237], v86 offset:10240
    v_mfma_f32_16x16x32_bf16 v[252:255], v[140:143], v[20:23], v[252:255]
    s_waitcnt lgkmcnt(3)
    ds_read_b64_tr_b16 v[238:239], v86 offset:10496
    v_mfma_f32_16x16x32_bf16 v[248:251], v[144:147], v[24:27], v[248:251]
    ds_read_b64_tr_b16 v[44:45], v86 offset:12288
    v_mfma_f32_16x16x32_bf16 v[248:251], v[152:155], v[88:91], v[248:251]
    ds_read_b64_tr_b16 v[46:47], v86 offset:12544
    v_mfma_f32_16x16x32_bf16 v[252:255], v[148:151], v[24:27], v[252:255]
    ds_read_b64_tr_b16 v[48:49], v86 offset:14336
    v_mfma_f32_16x16x32_bf16 v[252:255], v[156:159], v[88:91], v[252:255]
    s_waitcnt lgkmcnt(3)
    ds_read_b64_tr_b16 v[50:51], v86 offset:14592
    v_mfma_f32_16x16x32_bf16 v[248:251], v[200:203], v[232:235], v[248:251]
    v_mfma_f32_16x16x32_bf16 v[248:251], v[208:211], v[236:239], v[248:251]
    ds_write_b128 v80, v[60:63] offset:16896
    v_mfma_f32_16x16x32_bf16 v[252:255], v[204:207], v[232:235], v[252:255]
    v_mfma_f32_16x16x32_bf16 v[252:255], v[212:215], v[236:239], v[252:255]
    s_waitcnt lgkmcnt(3)
    v_mfma_f32_16x16x32_bf16 v[248:251], v[216:219], v[44:47], v[248:251]
    s_waitcnt lgkmcnt(1)
    v_mfma_f32_16x16x32_bf16 v[248:251], v[224:227], v[48:51], v[248:251]
    ds_write_b128 v80, v[68:71] offset:17920
    v_mfma_f32_16x16x32_bf16 v[252:255], v[220:223], v[44:47], v[252:255]
    v_mfma_f32_16x16x32_bf16 v[252:255], v[228:231], v[48:51], v[252:255]
    v_cvt_pk_bf16_f32 v28, v240, v241
    v_cvt_pk_bf16_f32 v29, v242, v243
    v_cvt_pk_bf16_f32 v30, v244, v245
    v_cvt_pk_bf16_f32 v31, v246, v247
    s_nop 0
    v_cvt_pk_bf16_f32 v32, v248, v249
    v_cvt_pk_bf16_f32 v33, v250, v251
    s_nop 0
    v_cvt_pk_bf16_f32 v34, v252, v253
    v_cvt_pk_bf16_f32 v35, v254, v255
    ds_write_b128 v82, v[28:31] offset:50688
    ds_write_b128 v82, v[32:35] offset:51712
    ds_read_b128 v[36:39], v83 offset:50688
    ds_read_b128 v[40:43], v83 offset:51712
    s_waitcnt lgkmcnt(0)
    s_barrier
    ds_read_b64_tr_b16 v[16:17], v85 offset:16896
    ds_read_b64_tr_b16 v[18:19], v85 offset:17152
    ds_read_b64_tr_b16 v[20:21], v85 offset:18944
    ds_read_b64_tr_b16 v[22:23], v85 offset:19200
    ds_read_b64_tr_b16 v[24:25], v85 offset:20992
    ds_read_b64_tr_b16 v[26:27], v85 offset:21248
    ds_read_b64_tr_b16 v[88:89], v85 offset:23040
    ds_read_b64_tr_b16 v[90:91], v85 offset:23296
    s_waitcnt lgkmcnt(6)
    v_mfma_f32_16x16x32_bf16 v[240:243], v[128:131], v[16:19], 0
    s_waitcnt lgkmcnt(4)
    ds_read_b64_tr_b16 v[232:233], v85 offset:25088
    v_mfma_f32_16x16x32_bf16 v[240:243], v[136:139], v[20:23], v[240:243]
    ds_read_b64_tr_b16 v[234:235], v85 offset:25344
    v_mfma_f32_16x16x32_bf16 v[244:247], v[132:135], v[16:19], 0
    ds_read_b64_tr_b16 v[236:237], v85 offset:27136
    v_mfma_f32_16x16x32_bf16 v[244:247], v[140:143], v[20:23], v[244:247]
    s_waitcnt lgkmcnt(3)
    ds_read_b64_tr_b16 v[238:239], v85 offset:27392
    s_add_u32 s53, s52, 40960
    buffer_store_dwordx4 v[36:39], v5, s[24:27], s53 offen sc0 sc1
    v_mfma_f32_16x16x32_bf16 v[240:243], v[144:147], v[24:27], v[240:243]
    ds_read_b64_tr_b16 v[44:45], v85 offset:29184
    v_mfma_f32_16x16x32_bf16 v[240:243], v[152:155], v[88:91], v[240:243]
    ds_read_b64_tr_b16 v[46:47], v85 offset:29440
    v_mfma_f32_16x16x32_bf16 v[244:247], v[148:151], v[24:27], v[244:247]
    ds_read_b64_tr_b16 v[48:49], v85 offset:31232
    v_mfma_f32_16x16x32_bf16 v[244:247], v[156:159], v[88:91], v[244:247]
    s_waitcnt lgkmcnt(3)
    ds_read_b64_tr_b16 v[50:51], v85 offset:31488
    s_add_u32 s53, s52, 49152
    buffer_store_dwordx4 v[40:43], v5, s[24:27], s53 offen sc0 sc1
    v_mfma_f32_16x16x32_bf16 v[240:243], v[200:203], v[232:235], v[240:243]
    ds_read_b64_tr_b16 v[16:17], v86 offset:16896
    v_mfma_f32_16x16x32_bf16 v[240:243], v[208:211], v[236:239], v[240:243]
    ds_read_b64_tr_b16 v[18:19], v86 offset:17152
    v_mfma_f32_16x16x32_bf16 v[244:247], v[204:207], v[232:235], v[244:247]
    ds_read_b64_tr_b16 v[20:21], v86 offset:18944
    v_mfma_f32_16x16x32_bf16 v[244:247], v[212:215], v[236:239], v[244:247]
    s_waitcnt lgkmcnt(3)
    ds_read_b64_tr_b16 v[22:23], v86 offset:19200
    v_mfma_f32_16x16x32_bf16 v[240:243], v[216:219], v[44:47], v[240:243]
    ds_read_b64_tr_b16 v[24:25], v86 offset:20992
    v_mfma_f32_16x16x32_bf16 v[240:243], v[224:227], v[48:51], v[240:243]
    ds_read_b64_tr_b16 v[26:27], v86 offset:21248
    v_mfma_f32_16x16x32_bf16 v[244:247], v[220:223], v[44:47], v[244:247]
    ds_read_b64_tr_b16 v[88:89], v86 offset:23040
    v_mfma_f32_16x16x32_bf16 v[244:247], v[228:231], v[48:51], v[244:247]
    s_waitcnt lgkmcnt(3)
    ds_read_b64_tr_b16 v[90:91], v86 offset:23296
    v_mfma_f32_16x16x32_bf16 v[248:251], v[128:131], v[16:19], 0
    ds_read_b64_tr_b16 v[232:233], v86 offset:25088
    v_mfma_f32_16x16x32_bf16 v[248:251], v[136:139], v[20:23], v[248:251]
    ds_read_b64_tr_b16 v[234:235], v86 offset:25344
    v_mfma_f32_16x16x32_bf16 v[252:255], v[132:135], v[16:19], 0
    ds_read_b64_tr_b16 v[236:237], v86 offset:27136
    v_mfma_f32_16x16x32_bf16 v[252:255], v[140:143], v[20:23], v[252:255]
    s_waitcnt lgkmcnt(3)
    ds_read_b64_tr_b16 v[238:239], v86 offset:27392
    v_mfma_f32_16x16x32_bf16 v[248:251], v[144:147], v[24:27], v[248:251]
    ds_read_b64_tr_b16 v[44:45], v86 offset:29184
    v_mfma_f32_16x16x32_bf16 v[248:251], v[152:155], v[88:91], v[248:251]
    ds_read_b64_tr_b16 v[46:47], v86 offset:29440
    v_mfma_f32_16x16x32_bf16 v[252:255], v[148:151], v[24:27], v[252:255]
    ds_read_b64_tr_b16 v[48:49], v86 offset:31232
    v_mfma_f32_16x16x32_bf16 v[252:255], v[156:159], v[88:91], v[252:255]
    s_waitcnt lgkmcnt(3)
    ds_read_b64_tr_b16 v[50:51], v86 offset:31488
    v_cvt_pk_bf16_f32 v28, v240, v241
    v_cvt_pk_bf16_f32 v29, v242, v243
    v_mfma_f32_16x16x32_bf16 v[248:251], v[200:203], v[232:235], v[248:251]
    v_mfma_f32_16x16x32_bf16 v[248:251], v[208:211], v[236:239], v[248:251]
    v_cvt_pk_bf16_f32 v30, v244, v245
    v_cvt_pk_bf16_f32 v31, v246, v247
    v_mfma_f32_16x16x32_bf16 v[252:255], v[204:207], v[232:235], v[252:255]
    v_mfma_f32_16x16x32_bf16 v[252:255], v[212:215], v[236:239], v[252:255]
    s_waitcnt lgkmcnt(2)
    ds_write_b128 v82, v[28:31] offset:50688
    v_mfma_f32_16x16x32_bf16 v[248:251], v[216:219], v[44:47], v[248:251]
    s_waitcnt lgkmcnt(1)
    v_mfma_f32_16x16x32_bf16 v[248:251], v[224:227], v[48:51], v[248:251]
    v_mfma_f32_16x16x32_bf16 v[252:255], v[220:223], v[44:47], v[252:255]
    v_mfma_f32_16x16x32_bf16 v[252:255], v[228:231], v[48:51], v[252:255]
    ds_read_b128 v[36:39], v83 offset:50688
    s_add_u32 s53, s52, 57344
    s_waitcnt lgkmcnt(0)
    buffer_store_dwordx4 v[36:39], v5, s[24:27], s53 offen sc0 sc1
    s_nop 1
    v_cvt_pk_bf16_f32 v32, v248, v249
    v_cvt_pk_bf16_f32 v33, v250, v251
    v_cvt_pk_bf16_f32 v34, v252, v253
    v_cvt_pk_bf16_f32 v35, v254, v255
    ds_write_b128 v82, v[32:35] offset:51712
    ds_read_b128 v[40:43], v83 offset:51712
    s_waitcnt lgkmcnt(0)
    buffer_store_dwordx4 v[40:43], v5, s[24:27], s63 offen sc0 sc1
    s_endpgm
    L_polla:
    s_add_u32 s53, s33, 6291712
    s_mov_b32 s54, 20000
    L_poll2a:
    buffer_load_dword v13, v7, s[4:7], s53 offen sc1
    s_sub_u32 s54, s54, 1
    s_cmp_eq_u32 s54, 0
    s_cbranch_scc1 L_gota
    s_waitcnt vmcnt(0)
    v_cmp_ne_u32 vcc, v13, v14
    s_nop 4
    s_cbranch_vccnz L_poll2a
    s_branch L_gota
    L_pollb:
    s_add_u32 s53, s33, 6291712
    s_mov_b32 s54, 20000
    L_poll2b:
    buffer_load_dword v13, v7, s[4:7], s53 offen sc1
    s_sub_u32 s54, s54, 1
    s_cmp_eq_u32 s54, 0
    s_cbranch_scc1 L_gotb
    s_waitcnt vmcnt(0)
    v_cmp_ne_u32 vcc, v13, v14
    s_nop 4
    s_cbranch_vccnz L_poll2b
    s_branch L_gotb
    .p2align 6
    L_trail:
    s_mov_b64 exec, 0
    s_cmp_eq_u32 s28, 4
    s_cbranch_scc1 L_pad0
    s_cmp_eq_u32 s28, 5
    s_cbranch_scc1 L_pad1
    s_cmp_eq_u32 s28, 6
    s_cbranch_scc1 L_pad2
    s_branch L_pad3
    L_ret0:
    s_mov_b64 exec, -1
    s_mov_b64 exec, 0
    s_cmp_eq_u32 s28, 4
    s_cbranch_scc1 L_pad4
    s_cmp_eq_u32 s28, 5
    s_cbranch_scc1 L_pad5
    s_cmp_eq_u32 s28, 6
    s_cbranch_scc1 L_pad6
    s_branch L_pad7
    L_pad6:
    L_pad7:
    L_ret1:
    s_mov_b64 exec, -1
    s_add_u32 s65, s64, 16384
    s_and_b32 s65, s65, 0x3ffff
    s_add_u32 s66, s65, 16384
    s_and_b32 s66, s66, 0x3ffff
    s_add_u32 s67, s66, 16384
    s_and_b32 s67, s67, 0x3ffff
    s_add_u32 s68, s67, 16384
    s_and_b32 s68, s68, 0x3ffff
    s_add_u32 s69, s68, 16384
    s_and_b32 s69, s69, 0x3ffff
    s_add_u32 s70, s69, 16384
    s_and_b32 s70, s70, 0x3ffff
    s_add_u32 s71, s70, 16384
    s_and_b32 s71, s71, 0x3ffff
    s_add_u32 s72, s71, 16384
    s_and_b32 s72, s72, 0x3ffff
    s_add_u32 s73, s72, 16384
    s_and_b32 s73, s73, 0x3ffff
    s_add_u32 s74, s73, 16384
    s_and_b32 s74, s74, 0x3ffff
    s_add_u32 s75, s74, 16384
    s_and_b32 s75, s75, 0x3ffff
    s_add_u32 s76, s75, 16384
    s_and_b32 s76, s76, 0x3ffff
    s_add_u32 s77, s76, 16384
    s_and_b32 s77, s77, 0x3ffff
    s_add_u32 s78, s77, 16384
    s_and_b32 s78, s78, 0x3ffff
    s_add_u32 s79, s78, 16384
    s_and_b32 s79, s79, 0x3ffff
    s_waitcnt lgkmcnt(0)
    s_barrier
    s_setprio 1
    s_add_u32 m0, s29, 0
    s_nop 0
    buffer_load_dwordx4 v4, s[12:15], s64 offen lds
    s_add_u32 m0, s29, 1536
    s_nop 0
    buffer_load_dwordx4 v4, s[12:15], s64 offen offset:512 lds
    s_add_u32 m0, s29, 1024
    s_nop 0
    buffer_load_dwordx4 v4, s[12:15], s65 offen lds
    s_add_u32 m0, s29, 2560
    s_nop 0
    buffer_load_dwordx4 v4, s[12:15], s65 offen offset:512 lds
    s_add_u32 m0, s29, 4096
    s_nop 0
    buffer_load_dwordx4 v4, s[12:15], s66 offen lds
    s_add_u32 m0, s29, 5120
    s_nop 0
    buffer_load_dwordx4 v4, s[12:15], s67 offen lds
    s_add_u32 m0, s29, 5632
    s_nop 0
    buffer_load_dwordx4 v4, s[12:15], s66 offen offset:512 lds
    s_add_u32 m0, s29, 6656
    s_nop 0
    buffer_load_dwordx4 v4, s[12:15], s67 offen offset:512 lds
    s_add_u32 m0, s29, 8192
    s_nop 0
    buffer_load_dwordx4 v4, s[12:15], s68 offen lds
    s_add_u32 m0, s29, 9216
    s_nop 0
    buffer_load_dwordx4 v4, s[12:15], s69 offen lds
    ds_read_b128 v[16:19], v1
    ds_read_b128 v[20:23], v1 offset:8448
    s_waitcnt vmcnt(7)
    ds_read_b64_tr_b16 v[128:129], v2
    ds_read_b64_tr_b16 v[130:131], v2 offset:256
    ds_read_b64_tr_b16 v[132:133], v7
    ds_read_b64_tr_b16 v[134:135], v7 offset:256
    s_waitcnt vmcnt(6)
    ds_read_b64_tr_b16 v[136:137], v2 offset:2048
    ds_read_b64_tr_b16 v[138:139], v2 offset:2304
    ds_read_b64_tr_b16 v[140:141], v7 offset:2048
    ds_read_b64_tr_b16 v[142:143], v7 offset:2304
    s_mov_b32 m0, s29
    s_add_u32 s54, s68, 512
    s_waitcnt lgkmcnt(4)
    buffer_load_dwordx4 v4, s[12:15], s54 offen lds
    s_add_u32 m0, s29, 512
    s_nop 0
    buffer_load_dwordx4 v4, s[12:15], s69 offen offset:512 lds
    v_mfma_f32_16x16x32_bf16 v[28:31], v[16:19], v[128:131], 0
    ds_read_b128 v[24:27], v1 offset:16896
    v_mfma_f32_16x16x32_bf16 v[36:39], v[16:19], v[132:135], 0
    s_waitcnt vmcnt(6) lgkmcnt(1)
    ds_read_b64_tr_b16 v[144:145], v2 offset:4096
    v_mfma_f32_16x16x32_bf16 v[44:47], v[16:19], v[136:139], 0
    ds_read_b64_tr_b16 v[146:147], v2 offset:4352
    L_pad3:
    s_cbranch_execz L_ret0
    s_add_u32 m0, s29, 2048
    v_mfma_f32_16x16x32_bf16 v[52:55], v[16:19], v[140:143], 0
    buffer_load_dwordx4 v4, s[12:15], s70 offen lds
    v_mfma_f32_16x16x32_bf16 v[32:35], v[20:23], v[128:131], 0
    ds_read_b128 v[16:19], v1 offset:25344
    v_mfma_f32_16x16x32_bf16 v[40:43], v[20:23], v[132:135], 0
    ds_read_b64_tr_b16 v[148:149], v7 offset:4096
    v_mfma_f32_16x16x32_bf16 v[48:51], v[20:23], v[136:139], 0
    ds_read_b64_tr_b16 v[150:151], v7 offset:4352
    s_add_u32 m0, s29, 3072
    v_mfma_f32_16x16x32_bf16 v[56:59], v[20:23], v[140:143], 0
    s_waitcnt lgkmcnt(5)
    buffer_load_dwordx4 v4, s[12:15], s71 offen lds
    v_mfma_f32_16x16x32_bf16 v[60:63], v[24:27], v[128:131], 0
    ds_read_b128 v[20:23], v1 offset:64
    v_mfma_f32_16x16x32_bf16 v[68:71], v[24:27], v[132:135], 0
    s_waitcnt vmcnt(6)
    ds_read_b64_tr_b16 v[152:153], v2 offset:6144
    v_mfma_f32_16x16x32_bf16 v[76:79], v[24:27], v[136:139], 0
    ds_read_b64_tr_b16 v[154:155], v2 offset:6400
    s_add_u32 m0, s29, 3584
    v_mfma_f32_16x16x32_bf16 v[84:87], v[24:27], v[140:143], 0
    s_waitcnt lgkmcnt(5)
    s_waitcnt lgkmcnt(3)
    buffer_load_dwordx4 v4, s[12:15], s70 offen offset:512 lds
    v_mfma_f32_16x16x32_bf16 v[64:67], v[16:19], v[128:131], 0
    ds_read_b128 v[24:27], v1 offset:8512
    ds_read_b64_tr_b16 v[156:157], v7 offset:6144
    v_mfma_f32_16x16x32_bf16 v[72:75], v[16:19], v[132:135], 0
    ds_read_b64_tr_b16 v[158:159], v7 offset:6400
    v_mfma_f32_16x16x32_bf16 v[80:83], v[16:19], v[136:139], 0
    s_add_u32 m0, s29, 4608
    v_mfma_f32_16x16x32_bf16 v[88:91], v[16:19], v[140:143], 0
    s_waitcnt lgkmcnt(5)
    buffer_load_dwordx4 v4, s[12:15], s71 offen offset:512 lds
    v_mfma_f32_16x16x32_bf16 v[28:31], v[20:23], v[144:147], v[28:31]
    ds_read_b128 v[16:19], v1 offset:16960
    v_mfma_f32_16x16x32_bf16 v[36:39], v[20:23], v[148:151], v[36:39]
    s_waitcnt vmcnt(6) lgkmcnt(1)
    ds_read_b64_tr_b16 v[160:161], v2 offset:8192
    v_mfma_f32_16x16x32_bf16 v[44:47], v[20:23], v[152:155], v[44:47]
    ds_read_b64_tr_b16 v[162:163], v2 offset:8448
    s_add_u32 m0, s29, 6144
    v_mfma_f32_16x16x32_bf16 v[52:55], v[20:23], v[156:159], v[52:55]
    buffer_load_dwordx4 v4, s[12:15], s72 offen lds
    v_mfma_f32_16x16x32_bf16 v[32:35], v[24:27], v[144:147], v[32:35]
    ds_read_b128 v[20:23], v1 offset:25408
    v_mfma_f32_16x16x32_bf16 v[40:43], v[24:27], v[148:151], v[40:43]
    ds_read_b64_tr_b16 v[164:165], v7 offset:8192
    v_mfma_f32_16x16x32_bf16 v[48:51], v[24:27], v[152:155], v[48:51]
    ds_read_b64_tr_b16 v[166:167], v7 offset:8448
    s_add_u32 m0, s29, 7168
    v_mfma_f32_16x16x32_bf16 v[56:59], v[24:27], v[156:159], v[56:59]
    s_waitcnt lgkmcnt(5)
    buffer_load_dwordx4 v4, s[12:15], s73 offen lds
    v_mfma_f32_16x16x32_bf16 v[60:63], v[16:19], v[144:147], v[60:63]
    ds_read_b128 v[24:27], v1 offset:128
    v_mfma_f32_16x16x32_bf16 v[68:71], v[16:19], v[148:151], v[68:71]
    s_waitcnt vmcnt(6)
    ds_read_b64_tr_b16 v[168:169], v2
    v_mfma_f32_16x16x32_bf16 v[76:79], v[16:19], v[152:155], v[76:79]
    ds_read_b64_tr_b16 v[170:171], v2 offset:256
    s_add_u32 m0, s29, 7680
    v_mfma_f32_16x16x32_bf16 v[84:87], v[16:19], v[156:159], v[84:87]
    s_waitcnt lgkmcnt(5)
    s_waitcnt lgkmcnt(3)
    buffer_load_dwordx4 v4, s[12:15], s72 offen offset:512 lds
    v_mfma_f32_16x16x32_bf16 v[64:67], v[20:23], v[144:147], v[64:67]
    ds_read_b128 v[16:19], v1 offset:8576
    ds_read_b64_tr_b16 v[172:173], v7
    v_mfma_f32_16x16x32_bf16 v[72:75], v[20:23], v[148:151], v[72:75]
    ds_read_b64_tr_b16 v[174:175], v7 offset:256
    v_mfma_f32_16x16x32_bf16 v[80:83], v[20:23], v[152:155], v[80:83]
    s_add_u32 m0, s29, 8704
    v_mfma_f32_16x16x32_bf16 v[88:91], v[20:23], v[156:159], v[88:91]
    s_waitcnt lgkmcnt(5)
    buffer_load_dwordx4 v4, s[12:15], s73 offen offset:512 lds
    v_mfma_f32_16x16x32_bf16 v[28:31], v[24:27], v[160:163], v[28:31]
    ds_read_b128 v[20:23], v1 offset:17024
    v_mfma_f32_16x16x32_bf16 v[36:39], v[24:27], v[164:167], v[36:39]
    s_waitcnt vmcnt(6) lgkmcnt(1)
    ds_read_b64_tr_b16 v[176:177], v2 offset:2048
    v_mfma_f32_16x16x32_bf16 v[44:47], v[24:27], v[168:171], v[44:47]
    ds_read_b64_tr_b16 v[178:179], v2 offset:2304
    s_add_u32 m0, s29, 0
    v_mfma_f32_16x16x32_bf16 v[52:55], v[24:27], v[172:175], v[52:55]
    buffer_load_dwordx4 v4, s[12:15], s74 offen lds
    v_mfma_f32_16x16x32_bf16 v[32:35], v[16:19], v[160:163], v[32:35]
    ds_read_b128 v[24:27], v1 offset:25472
    v_mfma_f32_16x16x32_bf16 v[40:43], v[16:19], v[164:167], v[40:43]
    ds_read_b64_tr_b16 v[180:181], v7 offset:2048
    v_mfma_f32_16x16x32_bf16 v[48:51], v[16:19], v[168:171], v[48:51]
    ds_read_b64_tr_b16 v[182:183], v7 offset:2304
    s_add_u32 m0, s29, 1024
    v_mfma_f32_16x16x32_bf16 v[56:59], v[16:19], v[172:175], v[56:59]
    s_waitcnt lgkmcnt(5)
    buffer_load_dwordx4 v4, s[12:15], s75 offen lds
    v_mfma_f32_16x16x32_bf16 v[60:63], v[20:23], v[160:163], v[60:63]
    ds_read_b128 v[16:19], v1 offset:192
    v_mfma_f32_16x16x32_bf16 v[68:71], v[20:23], v[164:167], v[68:71]
    s_waitcnt vmcnt(6)
    ds_read_b64_tr_b16 v[184:185], v2 offset:4096
    v_mfma_f32_16x16x32_bf16 v[76:79], v[20:23], v[168:171], v[76:79]
    ds_read_b64_tr_b16 v[186:187], v2 offset:4352
    s_add_u32 m0, s29, 1536
    v_mfma_f32_16x16x32_bf16 v[84:87], v[20:23], v[172:175], v[84:87]
    s_waitcnt lgkmcnt(5)
    s_waitcnt lgkmcnt(3)
    buffer_load_dwordx4 v4, s[12:15], s74 offen offset:512 lds
    v_mfma_f32_16x16x32_bf16 v[64:67], v[24:27], v[160:163], v[64:67]
    ds_read_b128 v[20:23], v1 offset:8640
    ds_read_b64_tr_b16 v[188:189], v7 offset:4096
    v_mfma_f32_16x16x32_bf16 v[72:75], v[24:27], v[164:167], v[72:75]
    ds_read_b64_tr_b16 v[190:191], v7 offset:4352
    v_mfma_f32_16x16x32_bf16 v[80:83], v[24:27], v[168:171], v[80:83]
    s_add_u32 m0, s29, 2560
    v_mfma_f32_16x16x32_bf16 v[88:91], v[24:27], v[172:175], v[88:91]
    s_waitcnt lgkmcnt(5)
    buffer_load_dwordx4 v4, s[12:15], s75 offen offset:512 lds
    v_mfma_f32_16x16x32_bf16 v[28:31], v[16:19], v[176:179], v[28:31]
    ds_read_b128 v[24:27], v1 offset:17088
    v_mfma_f32_16x16x32_bf16 v[36:39], v[16:19], v[180:183], v[36:39]
    s_waitcnt vmcnt(6) lgkmcnt(1)
    ds_read_b64_tr_b16 v[192:193], v2 offset:6144
    v_mfma_f32_16x16x32_bf16 v[44:47], v[16:19], v[184:187], v[44:47]
    ds_read_b64_tr_b16 v[194:195], v2 offset:6400
    s_add_u32 m0, s29, 4096
    v_mfma_f32_16x16x32_bf16 v[52:55], v[16:19], v[188:191], v[52:55]
    buffer_load_dwordx4 v4, s[12:15], s76 offen lds
    v_mfma_f32_16x16x32_bf16 v[32:35], v[20:23], v[176:179], v[32:35]
    ds_read_b128 v[16:19], v1 offset:25536
    v_mfma_f32_16x16x32_bf16 v[40:43], v[20:23], v[180:183], v[40:43]
    ds_read_b64_tr_b16 v[196:197], v7 offset:6144
    v_mfma_f32_16x16x32_bf16 v[48:51], v[20:23], v[184:187], v[48:51]
    ds_read_b64_tr_b16 v[198:199], v7 offset:6400
    s_add_u32 m0, s29, 5120
    v_mfma_f32_16x16x32_bf16 v[56:59], v[20:23], v[188:191], v[56:59]
    s_waitcnt lgkmcnt(5)
    buffer_load_dwordx4 v4, s[12:15], s77 offen lds
    v_mfma_f32_16x16x32_bf16 v[60:63], v[24:27], v[176:179], v[60:63]
    ds_read_b128 v[20:23], v1 offset:256
    v_mfma_f32_16x16x32_bf16 v[68:71], v[24:27], v[180:183], v[68:71]
    s_waitcnt vmcnt(6)
    ds_read_b64_tr_b16 v[200:201], v2 offset:8192
    v_mfma_f32_16x16x32_bf16 v[76:79], v[24:27], v[184:187], v[76:79]
    ds_read_b64_tr_b16 v[202:203], v2 offset:8448
    s_add_u32 m0, s29, 5632
    v_mfma_f32_16x16x32_bf16 v[84:87], v[24:27], v[188:191], v[84:87]
    s_waitcnt lgkmcnt(5)
    s_waitcnt lgkmcnt(3)
    buffer_load_dwordx4 v4, s[12:15], s76 offen offset:512 lds
    v_mfma_f32_16x16x32_bf16 v[64:67], v[16:19], v[176:179], v[64:67]
    ds_read_b128 v[24:27], v1 offset:8704
    ds_read_b64_tr_b16 v[204:205], v7 offset:8192
    v_mfma_f32_16x16x32_bf16 v[72:75], v[16:19], v[180:183], v[72:75]
    ds_read_b64_tr_b16 v[206:207], v7 offset:8448
    v_mfma_f32_16x16x32_bf16 v[80:83], v[16:19], v[184:187], v[80:83]
    s_add_u32 m0, s29, 6656
    v_mfma_f32_16x16x32_bf16 v[88:91], v[16:19], v[188:191], v[88:91]
    s_waitcnt lgkmcnt(5)
    buffer_load_dwordx4 v4, s[12:15], s77 offen offset:512 lds
    v_mfma_f32_16x16x32_bf16 v[28:31], v[20:23], v[192:195], v[28:31]
    ds_read_b128 v[16:19], v1 offset:17152
    v_mfma_f32_16x16x32_bf16 v[36:39], v[20:23], v[196:199], v[36:39]
    s_waitcnt vmcnt(6) lgkmcnt(1)
    ds_read_b64_tr_b16 v[208:209], v2
    v_mfma_f32_16x16x32_bf16 v[44:47], v[20:23], v[200:203], v[44:47]
    ds_read_b64_tr_b16 v[210:211], v2 offset:256
    s_add_u32 m0, s29, 8192
    v_mfma_f32_16x16x32_bf16 v[52:55], v[20:23], v[204:207], v[52:55]
    buffer_load_dwordx4 v4, s[12:15], s78 offen lds
    v_mfma_f32_16x16x32_bf16 v[32:35], v[24:27], v[192:195], v[32:35]
    ds_read_b128 v[20:23], v1 offset:25600
    v_mfma_f32_16x16x32_bf16 v[40:43], v[24:27], v[196:199], v[40:43]
    ds_read_b64_tr_b16 v[212:213], v7
    v_mfma_f32_16x16x32_bf16 v[48:51], v[24:27], v[200:203], v[48:51]
    ds_read_b64_tr_b16 v[214:215], v7 offset:256
    s_add_u32 m0, s29, 9216
    v_mfma_f32_16x16x32_bf16 v[56:59], v[24:27], v[204:207], v[56:59]
    s_waitcnt lgkmcnt(5)
    buffer_load_dwordx4 v4, s[12:15], s79 offen lds
    v_mfma_f32_16x16x32_bf16 v[60:63], v[16:19], v[192:195], v[60:63]
    ds_read_b128 v[24:27], v1 offset:320
    v_mfma_f32_16x16x32_bf16 v[68:71], v[16:19], v[196:199], v[68:71]
    s_waitcnt vmcnt(6)
    ds_read_b64_tr_b16 v[216:217], v2 offset:2048
    v_mfma_f32_16x16x32_bf16 v[76:79], v[16:19], v[200:203], v[76:79]
    ds_read_b64_tr_b16 v[218:219], v2 offset:2304
    s_mov_b32 m0, s29
    s_add_u32 s54, s78, 512
    v_mfma_f32_16x16x32_bf16 v[84:87], v[16:19], v[204:207], v[84:87]
    s_waitcnt lgkmcnt(5)
    s_waitcnt lgkmcnt(3)
    buffer_load_dwordx4 v4, s[12:15], s54 offen lds
    v_mfma_f32_16x16x32_bf16 v[64:67], v[20:23], v[192:195], v[64:67]
    ds_read_b128 v[16:19], v1 offset:8768
    ds_read_b64_tr_b16 v[220:221], v7 offset:2048
    v_mfma_f32_16x16x32_bf16 v[72:75], v[20:23], v[196:199], v[72:75]
    ds_read_b64_tr_b16 v[222:223], v7 offset:2304
    v_mfma_f32_16x16x32_bf16 v[80:83], v[20:23], v[200:203], v[80:83]
    s_add_u32 m0, s29, 512
    v_mfma_f32_16x16x32_bf16 v[88:91], v[20:23], v[204:207], v[88:91]
    s_waitcnt lgkmcnt(5)
    buffer_load_dwordx4 v4, s[12:15], s79 offen offset:512 lds
    s_barrier
    v_mfma_f32_16x16x32_bf16 v[28:31], v[24:27], v[208:211], v[28:31]
    ds_read_b128 v[20:23], v1 offset:17216
    v_mfma_f32_16x16x32_bf16 v[36:39], v[24:27], v[212:215], v[36:39]
    s_waitcnt vmcnt(6) lgkmcnt(1)
    ds_read_b64_tr_b16 v[224:225], v2 offset:4096
    v_mfma_f32_16x16x32_bf16 v[44:47], v[24:27], v[216:219], v[44:47]
    ds_read_b64_tr_b16 v[226:227], v2 offset:4352
    v_mfma_f32_16x16x32_bf16 v[52:55], v[24:27], v[220:223], v[52:55]
    v_mfma_f32_16x16x32_bf16 v[32:35], v[16:19], v[208:211], v[32:35]
    ds_read_b128 v[24:27], v1 offset:25664
    v_mfma_f32_16x16x32_bf16 v[40:43], v[16:19], v[212:215], v[40:43]
    ds_read_b64_tr_b16 v[228:229], v7 offset:4096
    v_mfma_f32_16x16x32_bf16 v[48:51], v[16:19], v[216:219], v[48:51]
    ds_read_b64_tr_b16 v[230:231], v7 offset:4352
    v_mfma_f32_16x16x32_bf16 v[56:59], v[16:19], v[220:223], v[56:59]
    s_waitcnt lgkmcnt(5)
    v_mfma_f32_16x16x32_bf16 v[60:63], v[20:23], v[208:211], v[60:63]
    ds_read_b128 v[16:19], v1 offset:384
    v_mfma_f32_16x16x32_bf16 v[68:71], v[20:23], v[212:215], v[68:71]
    s_waitcnt vmcnt(4)
    ds_read_b64_tr_b16 v[232:233], v2 offset:6144
    v_mfma_f32_16x16x32_bf16 v[76:79], v[20:23], v[216:219], v[76:79]
    ds_read_b64_tr_b16 v[234:235], v2 offset:6400
    v_mfma_f32_16x16x32_bf16 v[84:87], v[20:23], v[220:223], v[84:87]
    s_waitcnt lgkmcnt(5)
    v_mfma_f32_16x16x32_bf16 v[64:67], v[24:27], v[208:211], v[64:67]
    ds_read_b128 v[20:23], v1 offset:8832
    ds_read_b64_tr_b16 v[236:237], v7 offset:6144
    v_mfma_f32_16x16x32_bf16 v[72:75], v[24:27], v[212:215], v[72:75]
    ds_read_b64_tr_b16 v[238:239], v7 offset:6400
    v_mfma_f32_16x16x32_bf16 v[80:83], v[24:27], v[216:219], v[80:83]
    v_mfma_f32_16x16x32_bf16 v[88:91], v[24:27], v[220:223], v[88:91]
    s_waitcnt lgkmcnt(5)
    v_mfma_f32_16x16x32_bf16 v[28:31], v[16:19], v[224:227], v[28:31]
    ds_read_b128 v[24:27], v1 offset:17280
    v_mfma_f32_16x16x32_bf16 v[36:39], v[16:19], v[228:231], v[36:39]
    s_waitcnt vmcnt(2) lgkmcnt(1)
    ds_read_b64_tr_b16 v[240:241], v2 offset:8192
    v_mfma_f32_16x16x32_bf16 v[44:47], v[16:19], v[232:235], v[44:47]
    ds_read_b64_tr_b16 v[242:243], v2 offset:8448
    v_mfma_f32_16x16x32_bf16 v[52:55], v[16:19], v[236:239], v[52:55]
    v_mfma_f32_16x16x32_bf16 v[32:35], v[20:23], v[224:227], v[32:35]
    ds_read_b128 v[16:19], v1 offset:25728
    v_mfma_f32_16x16x32_bf16 v[40:43], v[20:23], v[228:231], v[40:43]
    ds_read_b64_tr_b16 v[244:245], v7 offset:8192
    v_mfma_f32_16x16x32_bf16 v[48:51], v[20:23], v[232:235], v[48:51]
    ds_read_b64_tr_b16 v[246:247], v7 offset:8448
    v_mfma_f32_16x16x32_bf16 v[56:59], v[20:23], v[236:239], v[56:59]
    s_waitcnt lgkmcnt(5)
    v_mfma_f32_16x16x32_bf16 v[60:63], v[24:27], v[224:227], v[60:63]
    ds_read_b128 v[20:23], v1 offset:448
    v_mfma_f32_16x16x32_bf16 v[68:71], v[24:27], v[228:231], v[68:71]
    s_waitcnt vmcnt(0)
    ds_read_b64_tr_b16 v[248:249], v2
    v_mfma_f32_16x16x32_bf16 v[76:79], v[24:27], v[232:235], v[76:79]
    ds_read_b64_tr_b16 v[250:251], v2 offset:256
    v_mfma_f32_16x16x32_bf16 v[84:87], v[24:27], v[236:239], v[84:87]
    s_waitcnt lgkmcnt(5)
    v_mfma_f32_16x16x32_bf16 v[64:67], v[16:19], v[224:227], v[64:67]
    ds_read_b128 v[24:27], v1 offset:8896
    ds_read_b64_tr_b16 v[252:253], v7
    v_mfma_f32_16x16x32_bf16 v[72:75], v[16:19], v[228:231], v[72:75]
    ds_read_b64_tr_b16 v[254:255], v7 offset:256
    v_mfma_f32_16x16x32_bf16 v[80:83], v[16:19], v[232:235], v[80:83]
    v_mfma_f32_16x16x32_bf16 v[88:91], v[16:19], v[236:239], v[88:91]
    s_waitcnt lgkmcnt(5)
    v_mfma_f32_16x16x32_bf16 v[28:31], v[20:23], v[240:243], v[28:31]
    ds_read_b128 v[16:19], v1 offset:17344
    v_mfma_f32_16x16x32_bf16 v[36:39], v[20:23], v[244:247], v[36:39]
    s_waitcnt lgkmcnt(1)
    v_mfma_f32_16x16x32_bf16 v[44:47], v[20:23], v[248:251], v[44:47]
    v_mfma_f32_16x16x32_bf16 v[52:55], v[20:23], v[252:255], v[52:55]
    v_mfma_f32_16x16x32_bf16 v[32:35], v[24:27], v[240:243], v[32:35]
    ds_read_b128 v[20:23], v1 offset:25792
    v_mfma_f32_16x16x32_bf16 v[40:43], v[24:27], v[244:247], v[40:43]
    v_mfma_f32_16x16x32_bf16 v[48:51], v[24:27], v[248:251], v[48:51]
    v_mfma_f32_16x16x32_bf16 v[56:59], v[24:27], v[252:255], v[56:59]
    s_waitcnt lgkmcnt(1)
    v_mfma_f32_16x16x32_bf16 v[60:63], v[16:19], v[240:243], v[60:63]
    v_mfma_f32_16x16x32_bf16 v[68:71], v[16:19], v[244:247], v[68:71]
    v_mfma_f32_16x16x32_bf16 v[76:79], v[16:19], v[248:251], v[76:79]
    v_mfma_f32_16x16x32_bf16 v[84:87], v[16:19], v[252:255], v[84:87]
    s_waitcnt lgkmcnt(0)
    v_mfma_f32_16x16x32_bf16 v[64:67], v[20:23], v[240:243], v[64:67]
    v_mfma_f32_16x16x32_bf16 v[72:75], v[20:23], v[244:247], v[72:75]
    v_mfma_f32_16x16x32_bf16 v[80:83], v[20:23], v[248:251], v[80:83]
    v_mfma_f32_16x16x32_bf16 v[88:91], v[20:23], v[252:255], v[88:91]
    v_bfe_u32 v15, v11, 2, 8
    s_add_u32 s53, s32, 6291456
    buffer_load_dword v13, v15, s[4:7], s53 offen sc1
    s_add_u32 s53, s33, 6291456
    buffer_load_dword v14, v15, s[4:7], s53 offen sc1
    v_mul_f32 v44, v8, v44
    v_mul_f32 v45, v8, v45
    v_exp_f32 v44, v44
    v_exp_f32 v45, v45
    v_mul_f32 v46, v8, v46
    v_mul_f32 v47, v8, v47
    v_exp_f32 v46, v46
    v_exp_f32 v47, v47
    v_fmaak_f32 v44, v44, v9, 0xbf317218
    v_fmaak_f32 v45, v45, v9, 0xbf317218
    v_rcp_f32 v44, v44
    v_rcp_f32 v45, v45
    v_fmaak_f32 v46, v46, v9, 0xbf317218
    v_fmaak_f32 v47, v47, v9, 0xbf317218
    v_rcp_f32 v46, v46
    v_rcp_f32 v47, v47
    v_mul_f32 v28, v28, v44
    v_mul_f32 v29, v29, v45
    v_cvt_pk_bf16_f32 v28, v28, v29
    v_mul_f32 v30, v30, v46
    v_mul_f32 v31, v31, v47
    v_cvt_pk_bf16_f32 v29, v30, v31
    v_mul_f32 v48, v8, v48
    v_mul_f32 v49, v8, v49
    v_exp_f32 v48, v48
    v_exp_f32 v49, v49
    v_mul_f32 v50, v8, v50
    v_mul_f32 v51, v8, v51
    v_exp_f32 v50, v50
    v_exp_f32 v51, v51
    v_fmaak_f32 v48, v48, v9, 0xbf317218
    v_fmaak_f32 v49, v49, v9, 0xbf317218
    v_rcp_f32 v48, v48
    v_rcp_f32 v49, v49
    v_fmaak_f32 v50, v50, v9, 0xbf317218
    v_fmaak_f32 v51, v51, v9, 0xbf317218
    v_rcp_f32 v50, v50
    v_rcp_f32 v51, v51
    v_mul_f32 v32, v32, v48
    v_mul_f32 v33, v33, v49
    v_cvt_pk_bf16_f32 v30, v32, v33
    v_mul_f32 v34, v34, v50
    v_mul_f32 v35, v35, v51
    v_cvt_pk_bf16_f32 v31, v34, v35
    ds_write_b128 v6, v[28:31]
    s_lshl_b32 s55, s32, 2
    s_add_u32 s55, s55, 1048576
    s_sub_u32 s55, s55, s29
    buffer_store_dwordx4 v[28:31], v6, s[4:7], s55 offen sc1
    v_mul_f32 v52, v8, v52
    v_mul_f32 v53, v8, v53
    v_exp_f32 v52, v52
    v_exp_f32 v53, v53
    v_mul_f32 v54, v8, v54
    v_mul_f32 v55, v8, v55
    v_exp_f32 v54, v54
    v_exp_f32 v55, v55
    v_fmaak_f32 v52, v52, v9, 0xbf317218
    v_fmaak_f32 v53, v53, v9, 0xbf317218
    v_rcp_f32 v52, v52
    v_rcp_f32 v53, v53
    v_fmaak_f32 v54, v54, v9, 0xbf317218
    v_fmaak_f32 v55, v55, v9, 0xbf317218
    v_rcp_f32 v54, v54
    v_rcp_f32 v55, v55
    v_mul_f32 v36, v36, v52
    v_mul_f32 v37, v37, v53
    v_cvt_pk_bf16_f32 v32, v36, v37
    v_mul_f32 v38, v38, v54
    v_mul_f32 v39, v39, v55
    v_cvt_pk_bf16_f32 v33, v38, v39
    v_mul_f32 v56, v8, v56
    v_mul_f32 v57, v8, v57
    v_exp_f32 v56, v56
    v_exp_f32 v57, v57
    v_mul_f32 v58, v8, v58
    v_mul_f32 v59, v8, v59
    v_exp_f32 v58, v58
    v_exp_f32 v59, v59
    v_fmaak_f32 v56, v56, v9, 0xbf317218
    v_fmaak_f32 v57, v57, v9, 0xbf317218
    v_rcp_f32 v56, v56
    v_rcp_f32 v57, v57
    v_fmaak_f32 v58, v58, v9, 0xbf317218
    v_fmaak_f32 v59, v59, v9, 0xbf317218
    v_rcp_f32 v58, v58
    v_rcp_f32 v59, v59
    v_mul_f32 v40, v40, v56
    v_mul_f32 v41, v41, v57
    v_cvt_pk_bf16_f32 v34, v40, v41
    v_mul_f32 v42, v42, v58
    v_mul_f32 v43, v43, v59
    v_cvt_pk_bf16_f32 v35, v42, v43
    ds_write_b128 v6, v[32:35] offset:256
    buffer_store_dwordx4 v[32:35], v6, s[4:7], s55 offen offset:256 sc1
    v_mul_f32 v76, v8, v76
    v_mul_f32 v77, v8, v77
    v_exp_f32 v76, v76
    v_exp_f32 v77, v77
    v_mul_f32 v78, v8, v78
    v_mul_f32 v79, v8, v79
    v_exp_f32 v78, v78
    v_exp_f32 v79, v79
    v_fmaak_f32 v76, v76, v9, 0xbf317218
    v_fmaak_f32 v77, v77, v9, 0xbf317218
    v_rcp_f32 v76, v76
    v_rcp_f32 v77, v77
    v_fmaak_f32 v78, v78, v9, 0xbf317218
    v_fmaak_f32 v79, v79, v9, 0xbf317218
    v_rcp_f32 v78, v78
    v_rcp_f32 v79, v79
    v_mul_f32 v60, v60, v76
    v_mul_f32 v61, v61, v77
    v_cvt_pk_bf16_f32 v60, v60, v61
    v_mul_f32 v62, v62, v78
    v_mul_f32 v63, v63, v79
    v_cvt_pk_bf16_f32 v61, v62, v63
    v_mul_f32 v80, v8, v80
    v_mul_f32 v81, v8, v81
    v_exp_f32 v80, v80
    v_exp_f32 v81, v81
    v_mul_f32 v82, v8, v82
    v_mul_f32 v83, v8, v83
    v_exp_f32 v82, v82
    v_exp_f32 v83, v83
    v_fmaak_f32 v80, v80, v9, 0xbf317218
    v_fmaak_f32 v81, v81, v9, 0xbf317218
    v_rcp_f32 v80, v80
    v_rcp_f32 v81, v81
    v_fmaak_f32 v82, v82, v9, 0xbf317218
    v_fmaak_f32 v83, v83, v9, 0xbf317218
    v_rcp_f32 v82, v82
    v_rcp_f32 v83, v83
    v_mul_f32 v64, v64, v80
    v_mul_f32 v65, v65, v81
    v_cvt_pk_bf16_f32 v62, v64, v65
    v_mul_f32 v66, v66, v82
    v_mul_f32 v67, v67, v83
    v_cvt_pk_bf16_f32 v63, v66, v67
    ds_write_b128 v6, v[60:63] offset:2048
    v_mul_f32 v84, v8, v84
    v_mul_f32 v85, v8, v85
    v_exp_f32 v84, v84
    v_exp_f32 v85, v85
    v_mul_f32 v86, v8, v86
    v_mul_f32 v87, v8, v87
    v_exp_f32 v86, v86
    v_exp_f32 v87, v87
    v_fmaak_f32 v84, v84, v9, 0xbf317218
    v_fmaak_f32 v85, v85, v9, 0xbf317218
    v_rcp_f32 v84, v84
    v_rcp_f32 v85, v85
    v_fmaak_f32 v86, v86, v9, 0xbf317218
    v_fmaak_f32 v87, v87, v9, 0xbf317218
    v_rcp_f32 v86, v86
    v_rcp_f32 v87, v87
    v_mul_f32 v68, v68, v84
    v_mul_f32 v69, v69, v85
    v_cvt_pk_bf16_f32 v64, v68, v69
    v_mul_f32 v70, v70, v86
    v_mul_f32 v71, v71, v87
    v_cvt_pk_bf16_f32 v65, v70, v71
    v_mul_f32 v88, v8, v88
    v_mul_f32 v89, v8, v89
    v_exp_f32 v88, v88
    v_exp_f32 v89, v89
    v_mul_f32 v90, v8, v90
    v_mul_f32 v91, v8, v91
    v_exp_f32 v90, v90
    v_exp_f32 v91, v91
    v_fmaak_f32 v88, v88, v9, 0xbf317218
    v_fmaak_f32 v89, v89, v9, 0xbf317218
    v_rcp_f32 v88, v88
    v_rcp_f32 v89, v89
    v_fmaak_f32 v90, v90, v9, 0xbf317218
    v_fmaak_f32 v91, v91, v9, 0xbf317218
    v_rcp_f32 v90, v90
    v_rcp_f32 v91, v91
    v_mul_f32 v72, v72, v88
    v_mul_f32 v73, v73, v89
    v_cvt_pk_bf16_f32 v66, v72, v73
    v_mul_f32 v74, v74, v90
    v_mul_f32 v75, v75, v91
    v_cvt_pk_bf16_f32 v67, v74, v75
    ds_write_b128 v6, v[64:67] offset:2304
    ds_read_b128 v[76:79], v12
    ds_read_b128 v[80:83], v12 offset:1024
    ds_read_b128 v[84:87], v12 offset:2048
    v_bfe_u32 v7, v11, 2, 8
    s_waitcnt lgkmcnt(2)
    ds_read_b128 v[28:31], v76
    ds_read_b128 v[32:35], v77
    ds_read_b128 v[36:39], v78
    ds_read_b128 v[40:43], v79
    ds_read_b128 v[44:47], v76 offset:2048
    ds_read_b128 v[48:51], v76 offset:256
    ds_read_b128 v[52:55], v77 offset:256
    ds_read_b128 v[56:59], v78 offset:256
    ds_read_b128 v[16:19], v79 offset:256
    ds_read_b128 v[20:23], v76 offset:2304
    s_waitcnt lgkmcnt(9)
    v_mfma_f32_4x4x4_16b_bf16 v[60:63], v[92:93], v[28:29], 0
    v_mfma_f32_4x4x4_16b_bf16 v[64:67], v[92:93], v[30:31], 0
    s_waitcnt lgkmcnt(4)
    v_mfma_f32_4x4x4_16b_bf16 v[68:71], v[110:111], v[48:49], 0
    v_mfma_f32_4x4x4_16b_bf16 v[72:75], v[110:111], v[50:51], 0
    v_mfma_f32_4x4x4_16b_bf16 v[60:63], v[94:95], v[30:31], v[60:63]
    v_mfma_f32_4x4x4_16b_bf16 v[64:67], v[94:95], v[32:33], v[64:67]
    v_mfma_f32_4x4x4_16b_bf16 v[68:71], v[112:113], v[50:51], v[68:71]
    s_waitcnt lgkmcnt(3)
    v_mfma_f32_4x4x4_16b_bf16 v[72:75], v[112:113], v[52:53], v[72:75]
    v_mfma_f32_4x4x4_16b_bf16 v[60:63], v[96:97], v[32:33], v[60:63]
    v_mfma_f32_4x4x4_16b_bf16 v[64:67], v[96:97], v[34:35], v[64:67]
    v_mfma_f32_4x4x4_16b_bf16 v[68:71], v[114:115], v[52:53], v[68:71]
    v_mfma_f32_4x4x4_16b_bf16 v[72:75], v[114:115], v[54:55], v[72:75]
    v_mfma_f32_4x4x4_16b_bf16 v[60:63], v[98:99], v[34:35], v[60:63]
    v_mfma_f32_4x4x4_16b_bf16 v[64:67], v[98:99], v[36:37], v[64:67]
    v_mfma_f32_4x4x4_16b_bf16 v[68:71], v[116:117], v[54:55], v[68:71]
    s_waitcnt lgkmcnt(2)
    v_mfma_f32_4x4x4_16b_bf16 v[72:75], v[116:117], v[56:57], v[72:75]
    s_barrier
    v_mfma_f32_4x4x4_16b_bf16 v[60:63], v[100:101], v[36:37], v[60:63]
    v_mfma_f32_4x4x4_16b_bf16 v[64:67], v[100:101], v[38:39], v[64:67]
    v_mfma_f32_4x4x4_16b_bf16 v[68:71], v[118:119], v[56:57], v[68:71]
    v_mfma_f32_4x4x4_16b_bf16 v[72:75], v[118:119], v[58:59], v[72:75]
    v_mfma_f32_4x4x4_16b_bf16 v[60:63], v[102:103], v[38:39], v[60:63]
    v_mfma_f32_4x4x4_16b_bf16 v[64:67], v[102:103], v[40:41], v[64:67]
    v_mfma_f32_4x4x4_16b_bf16 v[68:71], v[120:121], v[58:59], v[68:71]
    s_waitcnt lgkmcnt(1)
    v_mfma_f32_4x4x4_16b_bf16 v[72:75], v[120:121], v[16:17], v[72:75]
    v_mfma_f32_4x4x4_16b_bf16 v[60:63], v[104:105], v[40:41], v[60:63]
    v_mfma_f32_4x4x4_16b_bf16 v[64:67], v[104:105], v[42:43], v[64:67]
    v_mfma_f32_4x4x4_16b_bf16 v[68:71], v[122:123], v[16:17], v[68:71]
    v_mfma_f32_4x4x4_16b_bf16 v[72:75], v[122:123], v[18:19], v[72:75]
    v_mfma_f32_4x4x4_16b_bf16 v[60:63], v[106:107], v[42:43], v[60:63]
    v_mfma_f32_4x4x4_16b_bf16 v[64:67], v[106:107], v[44:45], v[64:67]
    v_mfma_f32_4x4x4_16b_bf16 v[68:71], v[124:125], v[18:19], v[68:71]
    s_waitcnt lgkmcnt(0)
    v_mfma_f32_4x4x4_16b_bf16 v[72:75], v[124:125], v[20:21], v[72:75]
    v_mfma_f32_4x4x4_16b_bf16 v[60:63], v[108:109], v[44:45], v[60:63]
    v_mfma_f32_4x4x4_16b_bf16 v[64:67], v[108:109], v[46:47], v[64:67]
    v_mfma_f32_4x4x4_16b_bf16 v[68:71], v[126:127], v[20:21], v[68:71]
    v_mfma_f32_4x4x4_16b_bf16 v[72:75], v[126:127], v[22:23], v[72:75]
    s_setprio 0
    ds_read_b128 v[16:19], v1 offset:33792
    ds_read_b128 v[20:23], v1 offset:33856
    v_exp_f32 v0, v60
    v_exp_f32 v15, v61
    v_fmaak_f32 v0, v0, v8, 0xbfb8aa3b
    v_fmaak_f32 v15, v15, v8, 0xbfb8aa3b
    v_rcp_f32 v0, v0
    v_rcp_f32 v15, v15
    v_mul_f32 v60, v60, v0
    v_mul_f32 v61, v61, v15
    v_exp_f32 v87, v62
    v_exp_f32 v4, v63
    v_fmaak_f32 v87, v87, v8, 0xbfb8aa3b
    v_fmaak_f32 v4, v4, v8, 0xbfb8aa3b
    v_rcp_f32 v87, v87
    v_rcp_f32 v4, v4
    v_mul_f32 v62, v62, v87
    v_mul_f32 v63, v63, v4
    v_exp_f32 v0, v64
    v_exp_f32 v15, v65
    v_fmaak_f32 v0, v0, v8, 0xbfb8aa3b
    v_fmaak_f32 v15, v15, v8, 0xbfb8aa3b
    v_rcp_f32 v0, v0
    v_rcp_f32 v15, v15
    v_mul_f32 v64, v64, v0
    v_mul_f32 v65, v65, v15
    v_exp_f32 v87, v66
    v_exp_f32 v4, v67
    v_fmaak_f32 v87, v87, v8, 0xbfb8aa3b
    v_fmaak_f32 v4, v4, v8, 0xbfb8aa3b
    v_rcp_f32 v87, v87
    v_rcp_f32 v4, v4
    v_mul_f32 v66, v66, v87
    v_mul_f32 v67, v67, v4
    v_cvt_pk_bf16_f32 v60, v60, v61
    v_cvt_pk_bf16_f32 v61, v62, v63
    v_cvt_pk_bf16_f32 v62, v64, v65
    v_cvt_pk_bf16_f32 v63, v66, v67
    v_exp_f32 v0, v68
    v_exp_f32 v15, v69
    v_fmaak_f32 v0, v0, v8, 0xbfb8aa3b
    v_fmaak_f32 v15, v15, v8, 0xbfb8aa3b
    v_rcp_f32 v0, v0
    v_rcp_f32 v15, v15
    v_mul_f32 v68, v68, v0
    v_mul_f32 v69, v69, v15
    v_exp_f32 v87, v70
    v_exp_f32 v4, v71
    v_fmaak_f32 v87, v87, v8, 0xbfb8aa3b
    v_fmaak_f32 v4, v4, v8, 0xbfb8aa3b
    v_rcp_f32 v87, v87
    v_rcp_f32 v4, v4
    v_mul_f32 v70, v70, v87
    v_mul_f32 v71, v71, v4
    v_exp_f32 v0, v72
    v_exp_f32 v15, v73
    v_fmaak_f32 v0, v0, v8, 0xbfb8aa3b
    v_fmaak_f32 v15, v15, v8, 0xbfb8aa3b
    v_rcp_f32 v0, v0
    v_rcp_f32 v15, v15
    v_mul_f32 v72, v72, v0
    v_mul_f32 v73, v73, v15
    v_exp_f32 v87, v74
    v_exp_f32 v4, v75
    v_fmaak_f32 v87, v87, v8, 0xbfb8aa3b
    v_fmaak_f32 v4, v4, v8, 0xbfb8aa3b
    v_rcp_f32 v87, v87
    v_rcp_f32 v4, v4
    v_mul_f32 v74, v74, v87
    v_mul_f32 v75, v75, v4
    v_cvt_pk_bf16_f32 v68, v68, v69
    v_cvt_pk_bf16_f32 v69, v70, v71
    v_cvt_pk_bf16_f32 v70, v72, v73
    v_cvt_pk_bf16_f32 v71, v74, v75
    s_waitcnt vmcnt(3)
    v_add_u32 v13, 2654435769, v13
    s_add_u32 s53, s32, 6291712
    s_waitcnt vmcnt(0)
    buffer_store_dword v13, v7, s[4:7], s53 offen sc1
    s_waitcnt lgkmcnt(1)
    v_mfma_f32_16x16x32_bf16 v[28:31], v[16:19], v[128:131], 0
    ds_read_b128 v[24:27], v1 offset:42240
    s_waitcnt lgkmcnt(1)
    v_mfma_f32_16x16x32_bf16 v[28:31], v[20:23], v[144:147], v[28:31]
    v_mfma_f32_16x16x32_bf16 v[36:39], v[16:19], v[132:135], 0
    ds_read_b128 v[88:91], v1 offset:42304
    v_mfma_f32_16x16x32_bf16 v[36:39], v[20:23], v[148:151], v[36:39]
    v_mfma_f32_16x16x32_bf16 v[44:47], v[16:19], v[136:139], 0
    v_mfma_f32_16x16x32_bf16 v[44:47], v[20:23], v[152:155], v[44:47]
    ds_write_b128 v80, v[60:63]
    v_mfma_f32_16x16x32_bf16 v[52:55], v[16:19], v[140:143], 0
    L_pad4:
    s_cbranch_execz L_ret1
    v_mfma_f32_16x16x32_bf16 v[52:55], v[20:23], v[156:159], v[52:55]
    s_waitcnt lgkmcnt(1)
    v_mfma_f32_16x16x32_bf16 v[32:35], v[24:27], v[128:131], 0
    ds_read_b128 v[16:19], v1 offset:33920
    v_mfma_f32_16x16x32_bf16 v[32:35], v[88:91], v[144:147], v[32:35]
    v_mfma_f32_16x16x32_bf16 v[40:43], v[24:27], v[132:135], 0
    ds_read_b128 v[20:23], v1 offset:33984
    v_mfma_f32_16x16x32_bf16 v[40:43], v[88:91], v[148:151], v[40:43]
    v_mfma_f32_16x16x32_bf16 v[48:51], v[24:27], v[136:139], 0
    v_mfma_f32_16x16x32_bf16 v[48:51], v[88:91], v[152:155], v[48:51]
    ds_write_b128 v80, v[68:71] offset:1024
    v_mfma_f32_16x16x32_bf16 v[56:59], v[24:27], v[140:143], 0
    v_mfma_f32_16x16x32_bf16 v[56:59], v[88:91], v[156:159], v[56:59]
    s_waitcnt lgkmcnt(1)
    v_mfma_f32_16x16x32_bf16 v[28:31], v[16:19], v[160:163], v[28:31]
    ds_read_b128 v[24:27], v1 offset:42368
    v_mfma_f32_16x16x32_bf16 v[28:31], v[20:23], v[176:179], v[28:31]
    v_mfma_f32_16x16x32_bf16 v[36:39], v[16:19], v[164:167], v[36:39]
    ds_read_b128 v[88:91], v1 offset:42432
    v_mfma_f32_16x16x32_bf16 v[36:39], v[20:23], v[180:183], v[36:39]
    v_mfma_f32_16x16x32_bf16 v[44:47], v[16:19], v[168:171], v[44:47]
    v_mfma_f32_16x16x32_bf16 v[44:47], v[20:23], v[184:187], v[44:47]
    v_mfma_f32_16x16x32_bf16 v[52:55], v[16:19], v[172:175], v[52:55]
    v_mfma_f32_16x16x32_bf16 v[52:55], v[20:23], v[188:191], v[52:55]
    s_waitcnt lgkmcnt(0)
    v_mfma_f32_16x16x32_bf16 v[32:35], v[24:27], v[160:163], v[32:35]
    ds_read_b128 v[16:19], v1 offset:34048
    v_mfma_f32_16x16x32_bf16 v[32:35], v[88:91], v[176:179], v[32:35]
    v_mfma_f32_16x16x32_bf16 v[40:43], v[24:27], v[164:167], v[40:43]
    ds_read_b128 v[20:23], v1 offset:34112
    v_mfma_f32_16x16x32_bf16 v[40:43], v[88:91], v[180:183], v[40:43]
    v_mfma_f32_16x16x32_bf16 v[48:51], v[24:27], v[168:171], v[48:51]
    v_mfma_f32_16x16x32_bf16 v[48:51], v[88:91], v[184:187], v[48:51]
    v_mfma_f32_16x16x32_bf16 v[56:59], v[24:27], v[172:175], v[56:59]
    s_setprio 1
    v_mfma_f32_16x16x32_bf16 v[56:59], v[88:91], v[188:191], v[56:59]
    s_waitcnt lgkmcnt(0)
    v_mfma_f32_16x16x32_bf16 v[28:31], v[16:19], v[192:195], v[28:31]
    ds_read_b128 v[24:27], v1 offset:42496
    v_mfma_f32_16x16x32_bf16 v[28:31], v[20:23], v[208:211], v[28:31]
    v_mfma_f32_16x16x32_bf16 v[36:39], v[16:19], v[196:199], v[36:39]
    ds_read_b128 v[88:91], v1 offset:42560
    v_mfma_f32_16x16x32_bf16 v[36:39], v[20:23], v[212:215], v[36:39]
    v_mfma_f32_16x16x32_bf16 v[44:47], v[16:19], v[200:203], v[44:47]
    v_mfma_f32_16x16x32_bf16 v[44:47], v[20:23], v[216:219], v[44:47]
    v_mfma_f32_16x16x32_bf16 v[52:55], v[16:19], v[204:207], v[52:55]
    v_mfma_f32_16x16x32_bf16 v[52:55], v[20:23], v[220:223], v[52:55]
    s_waitcnt lgkmcnt(0)
    v_mfma_f32_16x16x32_bf16 v[32:35], v[24:27], v[192:195], v[32:35]
    ds_read_b128 v[16:19], v1 offset:34176
    v_mfma_f32_16x16x32_bf16 v[32:35], v[88:91], v[208:211], v[32:35]
    s_add_u32 m0, s29, 6144
    v_mfma_f32_16x16x32_bf16 v[40:43], v[24:27], v[196:199], v[40:43]
    ds_read_b128 v[20:23], v1 offset:34240
    v_mfma_f32_16x16x32_bf16 v[40:43], v[88:91], v[212:215], v[40:43]
    buffer_load_dwordx4 v5, s[20:23], s36 offen lds
    v_mfma_f32_16x16x32_bf16 v[48:51], v[24:27], v[200:203], v[48:51]
    v_mfma_f32_16x16x32_bf16 v[48:51], v[88:91], v[216:219], v[48:51]
    v_mfma_f32_16x16x32_bf16 v[56:59], v[24:27], v[204:207], v[56:59]
    v_mfma_f32_16x16x32_bf16 v[56:59], v[88:91], v[220:223], v[56:59]
    s_waitcnt lgkmcnt(0)
    s_add_u32 m0, s29, 6144
    v_mfma_f32_16x16x32_bf16 v[28:31], v[16:19], v[224:227], v[28:31]
    ds_read_b128 v[24:27], v1 offset:42624
    v_mfma_f32_16x16x32_bf16 v[28:31], v[20:23], v[240:243], v[28:31]
    buffer_load_dwordx4 v5, s[20:23], s37 offen offset:1024 lds
    v_mfma_f32_16x16x32_bf16 v[36:39], v[16:19], v[228:231], v[36:39]
    ds_read_b128 v[88:91], v1 offset:42688
    v_mfma_f32_16x16x32_bf16 v[36:39], v[20:23], v[244:247], v[36:39]
    v_mfma_f32_16x16x32_bf16 v[44:47], v[16:19], v[232:235], v[44:47]
    v_mfma_f32_16x16x32_bf16 v[44:47], v[20:23], v[248:251], v[44:47]
    s_add_u32 m0, s29, 0
    v_mfma_f32_16x16x32_bf16 v[52:55], v[16:19], v[236:239], v[52:55]
    buffer_load_dwordx4 v5, s[20:23], s38 offen lds
    v_mfma_f32_16x16x32_bf16 v[52:55], v[20:23], v[252:255], v[52:55]
    s_waitcnt lgkmcnt(0)
    s_barrier
    v_mfma_f32_16x16x32_bf16 v[32:35], v[24:27], v[224:227], v[32:35]
    v_mfma_f32_16x16x32_bf16 v[32:35], v[88:91], v[240:243], v[32:35]
    v_mfma_f32_16x16x32_bf16 v[40:43], v[24:27], v[228:231], v[40:43]
    v_mfma_f32_16x16x32_bf16 v[40:43], v[88:91], v[244:247], v[40:43]
    s_add_u32 m0, s29, 0
    v_mfma_f32_16x16x32_bf16 v[48:51], v[24:27], v[232:235], v[48:51]
    v_mfma_f32_16x16x32_bf16 v[48:51], v[88:91], v[248:251], v[48:51]
    buffer_load_dwordx4 v5, s[20:23], s39 offen offset:1024 lds
    v_mfma_f32_16x16x32_bf16 v[56:59], v[24:27], v[236:239], v[56:59]
    v_mfma_f32_16x16x32_bf16 v[56:59], v[88:91], v[252:255], v[56:59]
    s_setprio 0
    v_mul_f32 v44, v8, v44
    s_add_u32 m0, s30, 0
    v_mul_f32 v45, v8, v45
    buffer_load_dwordx4 v5, s[20:23], s40 offen lds
    v_exp_f32 v44, v44
    v_exp_f32 v45, v45
    v_mul_f32 v46, v8, v46
    v_mul_f32 v47, v8, v47
    v_exp_f32 v46, v46
    v_exp_f32 v47, v47
    v_fmaak_f32 v44, v44, v9, 0xbf317218
    s_add_u32 m0, s30, 0
    v_fmaak_f32 v45, v45, v9, 0xbf317218
    buffer_load_dwordx4 v5, s[20:23], s41 offen offset:1024 lds
    v_rcp_f32 v44, v44
    v_rcp_f32 v45, v45
    v_fmaak_f32 v46, v46, v9, 0xbf317218
    v_fmaak_f32 v47, v47, v9, 0xbf317218
    v_rcp_f32 v46, v46
    v_rcp_f32 v47, v47
    v_mul_f32 v28, v28, v44
    s_add_u32 m0, s30, 0
    v_mul_f32 v29, v29, v45
    buffer_load_dwordx4 v5, s[20:23], s42 offen offset:2048 lds
    v_cvt_pk_bf16_f32 v60, v28, v29
    v_mul_f32 v30, v30, v46
    v_mul_f32 v31, v31, v47
    v_cvt_pk_bf16_f32 v61, v30, v31
    v_mul_f32 v48, v8, v48
    v_mul_f32 v49, v8, v49
    v_exp_f32 v48, v48
    s_add_u32 m0, s30, 0
    v_exp_f32 v49, v49
    buffer_load_dwordx4 v5, s[20:23], s43 offen offset:3072 lds
    v_mul_f32 v50, v8, v50
    v_mul_f32 v51, v8, v51
    v_exp_f32 v50, v50
    v_exp_f32 v51, v51
    v_fmaak_f32 v48, v48, v9, 0xbf317218
    v_fmaak_f32 v49, v49, v9, 0xbf317218
    v_rcp_f32 v48, v48
    v_rcp_f32 v49, v49
    v_fmaak_f32 v50, v50, v9, 0xbf317218
    v_fmaak_f32 v51, v51, v9, 0xbf317218
    v_rcp_f32 v50, v50
    v_rcp_f32 v51, v51
    v_mul_f32 v32, v32, v48
    v_mul_f32 v33, v33, v49
    v_cvt_pk_bf16_f32 v62, v32, v33
    v_mul_f32 v34, v34, v50
    v_mul_f32 v35, v35, v51
    v_cvt_pk_bf16_f32 v63, v34, v35
    v_mul_f32 v52, v8, v52
    v_mul_f32 v53, v8, v53
    v_exp_f32 v52, v52
    v_exp_f32 v53, v53
    v_mul_f32 v54, v8, v54
    v_mul_f32 v55, v8, v55
    v_exp_f32 v54, v54
    v_exp_f32 v55, v55
    v_fmaak_f32 v52, v52, v9, 0xbf317218
    v_fmaak_f32 v53, v53, v9, 0xbf317218
    v_rcp_f32 v52, v52
    v_rcp_f32 v53, v53
    v_fmaak_f32 v54, v54, v9, 0xbf317218
    v_fmaak_f32 v55, v55, v9, 0xbf317218
    v_rcp_f32 v54, v54
    v_rcp_f32 v55, v55
    v_mul_f32 v36, v36, v52
    v_mul_f32 v37, v37, v53
    v_cvt_pk_bf16_f32 v64, v36, v37
    v_mul_f32 v38, v38, v54
    v_mul_f32 v39, v39, v55
    v_cvt_pk_bf16_f32 v65, v38, v39
    v_mul_f32 v56, v8, v56
    v_mul_f32 v57, v8, v57
    v_exp_f32 v56, v56
    v_exp_f32 v57, v57
    v_mul_f32 v58, v8, v58
    v_mul_f32 v59, v8, v59
    v_exp_f32 v58, v58
    v_exp_f32 v59, v59
    v_fmaak_f32 v56, v56, v9, 0xbf317218
    v_fmaak_f32 v57, v57, v9, 0xbf317218
    v_rcp_f32 v56, v56
    v_rcp_f32 v57, v57
    v_fmaak_f32 v58, v58, v9, 0xbf317218
    v_fmaak_f32 v59, v59, v9, 0xbf317218
    v_rcp_f32 v58, v58
    v_rcp_f32 v59, v59
    v_mul_f32 v40, v40, v56
    v_mul_f32 v41, v41, v57
    v_cvt_pk_bf16_f32 v66, v40, v41
    v_mul_f32 v42, v42, v58
    v_mul_f32 v43, v43, v59
    v_cvt_pk_bf16_f32 v67, v42, v43
    ds_read_b128 v[16:19], v1 offset:50688
    ds_read_b128 v[20:23], v1 offset:50752
    s_waitcnt vmcnt(0)
    s_waitcnt lgkmcnt(1)
    v_mfma_f32_16x16x32_bf16 v[28:31], v[16:19], v[128:131], 0
    ds_read_b128 v[24:27], v1 offset:59136
    s_waitcnt lgkmcnt(1)
    v_mfma_f32_16x16x32_bf16 v[28:31], v[20:23], v[144:147], v[28:31]
    ds_write_b128 v6, v[60:63] offset:4096
    v_mfma_f32_16x16x32_bf16 v[36:39], v[16:19], v[132:135], 0
    ds_read_b128 v[88:91], v1 offset:59200
    v_mfma_f32_16x16x32_bf16 v[36:39], v[20:23], v[148:151], v[36:39]
    v_mfma_f32_16x16x32_bf16 v[44:47], v[16:19], v[136:139], 0
    v_mfma_f32_16x16x32_bf16 v[44:47], v[20:23], v[152:155], v[44:47]
    ds_write_b128 v6, v[64:67] offset:4352
    v_mfma_f32_16x16x32_bf16 v[52:55], v[16:19], v[140:143], 0
    v_mfma_f32_16x16x32_bf16 v[52:55], v[20:23], v[156:159], v[52:55]
    s_waitcnt lgkmcnt(1)
    v_mfma_f32_16x16x32_bf16 v[32:35], v[24:27], v[128:131], 0
    ds_read_b128 v[16:19], v1 offset:50816
    v_mfma_f32_16x16x32_bf16 v[32:35], v[88:91], v[144:147], v[32:35]
    v_mfma_f32_16x16x32_bf16 v[40:43], v[24:27], v[132:135], 0
    ds_read_b128 v[20:23], v1 offset:50880
    v_mfma_f32_16x16x32_bf16 v[40:43], v[88:91], v[148:151], v[40:43]
    v_mfma_f32_16x16x32_bf16 v[48:51], v[24:27], v[136:139], 0
    v_mfma_f32_16x16x32_bf16 v[48:51], v[88:91], v[152:155], v[48:51]
    v_mfma_f32_16x16x32_bf16 v[56:59], v[24:27], v[140:143], 0
    v_mfma_f32_16x16x32_bf16 v[56:59], v[88:91], v[156:159], v[56:59]
    s_waitcnt lgkmcnt(0)
    v_mfma_f32_16x16x32_bf16 v[28:31], v[16:19], v[160:163], v[28:31]
    ds_read_b128 v[24:27], v1 offset:59264
    v_mfma_f32_16x16x32_bf16 v[28:31], v[20:23], v[176:179], v[28:31]
    ds_read_b64_tr_b16 v[128:129], v81 offset:6144
    ds_read_b64_tr_b16 v[130:131], v81 offset:6400
    v_mfma_f32_16x16x32_bf16 v[36:39], v[16:19], v[164:167], v[36:39]
    ds_read_b128 v[88:91], v1 offset:59328
    v_mfma_f32_16x16x32_bf16 v[36:39], v[20:23], v[180:183], v[36:39]
    ds_read_b64_tr_b16 v[132:133], v81 offset:6152
    ds_read_b64_tr_b16 v[134:135], v81 offset:6408
    v_mfma_f32_16x16x32_bf16 v[44:47], v[16:19], v[168:171], v[44:47]
    ds_read_b64_tr_b16 v[136:137], v81
    v_mfma_f32_16x16x32_bf16 v[44:47], v[20:23], v[184:187], v[44:47]
    ds_read_b64_tr_b16 v[138:139], v81 offset:256
    v_mfma_f32_16x16x32_bf16 v[52:55], v[16:19], v[172:175], v[52:55]
    ds_read_b64_tr_b16 v[140:141], v81 offset:8
    v_mfma_f32_16x16x32_bf16 v[52:55], v[20:23], v[188:191], v[52:55]
    s_waitcnt lgkmcnt(5)
    ds_read_b64_tr_b16 v[142:143], v81 offset:264
    v_mfma_f32_16x16x32_bf16 v[32:35], v[24:27], v[160:163], v[32:35]
    ds_read_b128 v[16:19], v1 offset:50944
    v_mfma_f32_16x16x32_bf16 v[32:35], v[88:91], v[176:179], v[32:35]
    ds_read_b64_tr_b16 v[144:145], v84
    ds_read_b64_tr_b16 v[146:147], v84 offset:256
    v_mfma_f32_16x16x32_bf16 v[40:43], v[24:27], v[164:167], v[40:43]
    ds_read_b128 v[20:23], v1 offset:51008
    v_mfma_f32_16x16x32_bf16 v[40:43], v[88:91], v[180:183], v[40:43]
    ds_read_b64_tr_b16 v[148:149], v84 offset:8
    ds_read_b64_tr_b16 v[150:151], v84 offset:264
    v_mfma_f32_16x16x32_bf16 v[48:51], v[24:27], v[168:171], v[48:51]
    ds_read_b64_tr_b16 v[152:153], v84 offset:2048
    v_mfma_f32_16x16x32_bf16 v[48:51], v[88:91], v[184:187], v[48:51]
    ds_read_b64_tr_b16 v[154:155], v84 offset:2304
    s_add_u32 m0, s29, 6144
    v_mfma_f32_16x16x32_bf16 v[56:59], v[24:27], v[172:175], v[56:59]
    s_setprio 1
    ds_read_b64_tr_b16 v[156:157], v84 offset:2056
    v_mfma_f32_16x16x32_bf16 v[56:59], v[88:91], v[188:191], v[56:59]
    s_waitcnt lgkmcnt(5)
    ds_read_b64_tr_b16 v[158:159], v84 offset:2312
    buffer_load_dwordx4 v5, s[20:23], s44 offen lds
    v_mfma_f32_16x16x32_bf16 v[28:31], v[16:19], v[192:195], v[28:31]
    ds_read_b128 v[24:27], v1 offset:59392
    v_mfma_f32_16x16x32_bf16 v[28:31], v[20:23], v[208:211], v[28:31]
    v_mfma_f32_16x16x32_bf16 v[36:39], v[16:19], v[196:199], v[36:39]
    ds_read_b128 v[88:91], v1 offset:59456
    v_mfma_f32_16x16x32_bf16 v[36:39], v[20:23], v[212:215], v[36:39]
    ds_read_b128 v[160:163], v76 offset:2048
    s_add_u32 m0, s29, 6144
    v_mfma_f32_16x16x32_bf16 v[44:47], v[16:19], v[200:203], v[44:47]
    v_mfma_f32_16x16x32_bf16 v[44:47], v[20:23], v[216:219], v[44:47]
    buffer_load_dwordx4 v5, s[20:23], s45 offen offset:1024 lds
    v_mfma_f32_16x16x32_bf16 v[52:55], v[16:19], v[204:207], v[52:55]
    v_mfma_f32_16x16x32_bf16 v[52:55], v[20:23], v[220:223], v[52:55]
    s_waitcnt lgkmcnt(1)
    ds_read_b128 v[164:167], v77 offset:2048
    v_mfma_f32_16x16x32_bf16 v[32:35], v[24:27], v[192:195], v[32:35]
    ds_read_b128 v[16:19], v1 offset:51072
    v_mfma_f32_16x16x32_bf16 v[32:35], v[88:91], v[208:211], v[32:35]
    ds_read_b128 v[168:171], v78 offset:2048
    s_add_u32 m0, s29, 0
    v_mfma_f32_16x16x32_bf16 v[40:43], v[24:27], v[196:199], v[40:43]
    ds_read_b128 v[20:23], v1 offset:51136
    v_mfma_f32_16x16x32_bf16 v[40:43], v[88:91], v[212:215], v[40:43]
    buffer_load_dwordx4 v5, s[20:23], s46 offen lds
    v_mfma_f32_16x16x32_bf16 v[48:51], v[24:27], v[200:203], v[48:51]
    ds_read_b128 v[172:175], v79 offset:2048
    v_add_u32 v14, 2654435769, v14
    v_mfma_f32_16x16x32_bf16 v[48:51], v[88:91], v[216:219], v[48:51]
    s_add_u32 s53, s33, 6291712
    buffer_load_dword v13, v7, s[4:7], s53 offen sc1
    v_mfma_f32_16x16x32_bf16 v[56:59], v[24:27], v[204:207], v[56:59]
    ds_read_b128 v[176:179], v76 offset:4096
    v_mfma_f32_16x16x32_bf16 v[56:59], v[88:91], v[220:223], v[56:59]
    s_waitcnt lgkmcnt(2)
    s_add_u32 m0, s29, 0
    v_mfma_f32_16x16x32_bf16 v[28:31], v[16:19], v[224:227], v[28:31]
    ds_read_b128 v[24:27], v1 offset:59520
    v_mfma_f32_16x16x32_bf16 v[28:31], v[20:23], v[240:243], v[28:31]
    buffer_load_dwordx4 v5, s[20:23], s47 offen offset:1024 lds
    v_mfma_f32_16x16x32_bf16 v[36:39], v[16:19], v[228:231], v[36:39]
    ds_read_b128 v[88:91], v1 offset:59584
    v_mfma_f32_16x16x32_bf16 v[36:39], v[20:23], v[244:247], v[36:39]
    ds_read_b128 v[180:183], v76 offset:2304
    v_mfma_f32_16x16x32_bf16 v[44:47], v[16:19], v[232:235], v[44:47]
    v_mfma_f32_16x16x32_bf16 v[44:47], v[20:23], v[248:251], v[44:47]
    ds_read_b128 v[184:187], v77 offset:2304
    v_mfma_f32_16x16x32_bf16 v[52:55], v[16:19], v[236:239], v[52:55]
    v_mfma_f32_16x16x32_bf16 v[52:55], v[20:23], v[252:255], v[52:55]
    s_waitcnt lgkmcnt(2)
    v_mfma_f32_16x16x32_bf16 v[32:35], v[24:27], v[224:227], v[32:35]
    v_mfma_f32_16x16x32_bf16 v[32:35], v[88:91], v[240:243], v[32:35]
    ds_read_b128 v[188:191], v78 offset:2304
    v_mfma_f32_16x16x32_bf16 v[40:43], v[24:27], v[228:231], v[40:43]
    v_mfma_f32_16x16x32_bf16 v[40:43], v[88:91], v[244:247], v[40:43]
    ds_read_b128 v[192:195], v79 offset:2304
    v_mfma_f32_16x16x32_bf16 v[48:51], v[24:27], v[232:235], v[48:51]
    v_mfma_f32_16x16x32_bf16 v[48:51], v[88:91], v[248:251], v[48:51]
    ds_read_b128 v[196:199], v76 offset:4352
    v_mfma_f32_16x16x32_bf16 v[56:59], v[24:27], v[236:239], v[56:59]
    v_mfma_f32_16x16x32_bf16 v[56:59], v[88:91], v[252:255], v[56:59]
    s_setprio 0
    v_mul_f32 v44, v8, v44
    s_add_u32 m0, s30, 0
    v_mul_f32 v45, v8, v45
    buffer_load_dwordx4 v5, s[20:23], s48 offen lds
    v_exp_f32 v44, v44
    v_exp_f32 v45, v45
    v_mul_f32 v46, v8, v46
    v_mul_f32 v47, v8, v47
    v_exp_f32 v46, v46
    v_exp_f32 v47, v47
    s_waitcnt vmcnt(4)
    ds_read_b64_tr_b16 v[200:201], v81 offset:6144
    ds_read_b64_tr_b16 v[202:203], v81 offset:6400
    ds_read_b64_tr_b16 v[204:205], v81 offset:6152
    ds_read_b64_tr_b16 v[206:207], v81 offset:6408
    v_fmaak_f32 v44, v44, v9, 0xbf317218
    s_add_u32 m0, s30, 0
    v_fmaak_f32 v45, v45, v9, 0xbf317218
    buffer_load_dwordx4 v5, s[20:23], s49 offen offset:1024 lds
    v_rcp_f32 v44, v44
    v_rcp_f32 v45, v45
    v_fmaak_f32 v46, v46, v9, 0xbf317218
    v_fmaak_f32 v47, v47, v9, 0xbf317218
    v_rcp_f32 v46, v46
    v_rcp_f32 v47, v47
    v_mul_f32 v28, v28, v44
    s_add_u32 m0, s30, 0
    v_mul_f32 v29, v29, v45
    buffer_load_dwordx4 v5, s[20:23], s50 offen offset:2048 lds
    v_cvt_pk_bf16_f32 v28, v28, v29
    v_mul_f32 v30, v30, v46
    v_mul_f32 v31, v31, v47
    v_cvt_pk_bf16_f32 v29, v30, v31
    v_mul_f32 v48, v8, v48
    v_mul_f32 v49, v8, v49
    v_exp_f32 v48, v48
    s_add_u32 m0, s30, 0
    v_exp_f32 v49, v49
    buffer_load_dwordx4 v5, s[20:23], s51 offen offset:3072 lds
    v_mul_f32 v50, v8, v50
    v_mul_f32 v51, v8, v51
    v_exp_f32 v50, v50
    v_exp_f32 v51, v51
    v_fmaak_f32 v48, v48, v9, 0xbf317218
    v_fmaak_f32 v49, v49, v9, 0xbf317218
    v_rcp_f32 v48, v48
    v_rcp_f32 v49, v49
    v_fmaak_f32 v50, v50, v9, 0xbf317218
    v_fmaak_f32 v51, v51, v9, 0xbf317218
    v_rcp_f32 v50, v50
    v_rcp_f32 v51, v51
    v_mul_f32 v32, v32, v48
    v_mul_f32 v33, v33, v49
    v_cvt_pk_bf16_f32 v30, v32, v33
    v_mul_f32 v34, v34, v50
    v_mul_f32 v35, v35, v51
    v_cvt_pk_bf16_f32 v31, v34, v35
    v_mul_f32 v52, v8, v52
    v_mul_f32 v53, v8, v53
    v_exp_f32 v52, v52
    v_exp_f32 v53, v53
    v_mul_f32 v54, v8, v54
    v_mul_f32 v55, v8, v55
    v_exp_f32 v54, v54
    v_exp_f32 v55, v55
    v_fmaak_f32 v52, v52, v9, 0xbf317218
    v_fmaak_f32 v53, v53, v9, 0xbf317218
    v_rcp_f32 v52, v52
    v_rcp_f32 v53, v53
    v_fmaak_f32 v54, v54, v9, 0xbf317218
    v_fmaak_f32 v55, v55, v9, 0xbf317218
    v_rcp_f32 v54, v54
    v_rcp_f32 v55, v55
    v_mul_f32 v36, v36, v52
    v_mul_f32 v37, v37, v53
    v_cvt_pk_bf16_f32 v32, v36, v37
    v_mul_f32 v38, v38, v54
    v_mul_f32 v39, v39, v55
    v_cvt_pk_bf16_f32 v33, v38, v39
    v_mul_f32 v56, v8, v56
    v_mul_f32 v57, v8, v57
    v_exp_f32 v56, v56
    v_exp_f32 v57, v57
    v_mul_f32 v58, v8, v58
    v_mul_f32 v59, v8, v59
    v_exp_f32 v58, v58
    v_exp_f32 v59, v59
    v_fmaak_f32 v56, v56, v9, 0xbf317218
    v_fmaak_f32 v57, v57, v9, 0xbf317218
    v_rcp_f32 v56, v56
    v_rcp_f32 v57, v57
    v_fmaak_f32 v58, v58, v9, 0xbf317218
    v_fmaak_f32 v59, v59, v9, 0xbf317218
    v_rcp_f32 v58, v58
    v_rcp_f32 v59, v59
    v_mul_f32 v40, v40, v56
    v_mul_f32 v41, v41, v57
    v_cvt_pk_bf16_f32 v34, v40, v41
    v_mul_f32 v42, v42, v58
    v_mul_f32 v43, v43, v59
    v_cvt_pk_bf16_f32 v35, v42, v43
    s_waitcnt lgkmcnt(0)
    ds_write_b128 v6, v[28:31] offset:6144
    ds_write_b128 v6, v[32:35] offset:6400
    s_waitcnt vmcnt(0)
    v_cmp_ne_u32 vcc, v13, v14
    s_lshl_b32 s55, s33, 2
    s_add_u32 s55, s55, 1048576
    s_cmp_lt_u32 s33, s32
    s_cselect_b32 s61, 2, 8
    s_lshl_b32 s61, s61, 10
    s_add_u32 m0, s61, s29
    s_cbranch_vccnz L_pollb
    L_gotb:
    s_add_u32 s54, s33, 6291456
    buffer_load_dwordx4 v11, s[4:7], s55 offen sc1 lds
    buffer_load_dwordx4 v11, s[4:7], s55 offen offset:1024 sc1 lds
    buffer_store_dword v14, v7, s[4:7], s54 offen sc1
    s_barrier
    v_mfma_f32_4x4x4_16b_bf16 v[60:63], v[92:93], v[160:161], 0
    ds_read_b64_tr_b16 v[16:17], v85
    v_mfma_f32_4x4x4_16b_bf16 v[64:67], v[92:93], v[162:163], 0
    ds_read_b64_tr_b16 v[18:19], v85 offset:256
    v_mfma_f32_4x4x4_16b_bf16 v[68:71], v[110:111], v[180:181], 0
    ds_read_b64_tr_b16 v[20:21], v85 offset:2048
    v_mfma_f32_4x4x4_16b_bf16 v[72:75], v[110:111], v[182:183], 0
    ds_read_b64_tr_b16 v[22:23], v85 offset:2304
    v_mfma_f32_4x4x4_16b_bf16 v[60:63], v[94:95], v[162:163], v[60:63]
    ds_read_b64_tr_b16 v[24:25], v85 offset:4096
    v_mfma_f32_4x4x4_16b_bf16 v[64:67], v[94:95], v[164:165], v[64:67]
    ds_read_b64_tr_b16 v[26:27], v85 offset:4352
    v_mfma_f32_4x4x4_16b_bf16 v[68:71], v[112:113], v[182:183], v[68:71]
    ds_read_b64_tr_b16 v[88:89], v85 offset:6144
    v_mfma_f32_4x4x4_16b_bf16 v[72:75], v[112:113], v[184:185], v[72:75]
    ds_read_b64_tr_b16 v[90:91], v85 offset:6400
    v_mfma_f32_4x4x4_16b_bf16 v[60:63], v[96:97], v[164:165], v[60:63]
    ds_read_b64_tr_b16 v[232:233], v85 offset:8192
    v_mfma_f32_4x4x4_16b_bf16 v[64:67], v[96:97], v[166:167], v[64:67]
    ds_read_b64_tr_b16 v[234:235], v85 offset:8448
    v_mfma_f32_4x4x4_16b_bf16 v[68:71], v[114:115], v[184:185], v[68:71]
    ds_read_b64_tr_b16 v[236:237], v85 offset:10240
    v_mfma_f32_4x4x4_16b_bf16 v[72:75], v[114:115], v[186:187], v[72:75]
    ds_read_b64_tr_b16 v[238:239], v85 offset:10496
    v_mfma_f32_4x4x4_16b_bf16 v[60:63], v[98:99], v[166:167], v[60:63]
    ds_read_b64_tr_b16 v[208:209], v81
    v_mfma_f32_4x4x4_16b_bf16 v[64:67], v[98:99], v[168:169], v[64:67]
    ds_read_b64_tr_b16 v[210:211], v81 offset:256
    v_mfma_f32_4x4x4_16b_bf16 v[68:71], v[116:117], v[186:187], v[68:71]
    ds_read_b64_tr_b16 v[212:213], v81 offset:8
    v_mfma_f32_4x4x4_16b_bf16 v[72:75], v[116:117], v[188:189], v[72:75]
    ds_read_b64_tr_b16 v[214:215], v81 offset:264
    v_mfma_f32_4x4x4_16b_bf16 v[60:63], v[100:101], v[168:169], v[60:63]
    ds_read_b64_tr_b16 v[216:217], v84
    v_mfma_f32_4x4x4_16b_bf16 v[64:67], v[100:101], v[170:171], v[64:67]
    ds_read_b64_tr_b16 v[218:219], v84 offset:256
    v_mfma_f32_4x4x4_16b_bf16 v[68:71], v[118:119], v[188:189], v[68:71]
    ds_read_b64_tr_b16 v[220:221], v84 offset:8
    v_mfma_f32_4x4x4_16b_bf16 v[72:75], v[118:119], v[190:191], v[72:75]
    ds_read_b64_tr_b16 v[222:223], v84 offset:264
    v_mfma_f32_4x4x4_16b_bf16 v[60:63], v[102:103], v[170:171], v[60:63]
    ds_read_b64_tr_b16 v[224:225], v84 offset:2048
    v_mfma_f32_4x4x4_16b_bf16 v[64:67], v[102:103], v[172:173], v[64:67]
    ds_read_b64_tr_b16 v[226:227], v84 offset:2304
    v_mfma_f32_4x4x4_16b_bf16 v[68:71], v[120:121], v[190:191], v[68:71]
    ds_read_b64_tr_b16 v[228:229], v84 offset:2056
    v_mfma_f32_4x4x4_16b_bf16 v[72:75], v[120:121], v[192:193], v[72:75]
    ds_read_b64_tr_b16 v[230:231], v84 offset:2312
    v_mfma_f32_4x4x4_16b_bf16 v[60:63], v[104:105], v[172:173], v[60:63]
    v_mfma_f32_4x4x4_16b_bf16 v[64:67], v[104:105], v[174:175], v[64:67]
    v_mfma_f32_4x4x4_16b_bf16 v[68:71], v[122:123], v[192:193], v[68:71]
    v_mfma_f32_4x4x4_16b_bf16 v[72:75], v[122:123], v[194:195], v[72:75]
    v_mfma_f32_4x4x4_16b_bf16 v[60:63], v[106:107], v[174:175], v[60:63]
    v_mfma_f32_4x4x4_16b_bf16 v[64:67], v[106:107], v[176:177], v[64:67]
    v_mfma_f32_4x4x4_16b_bf16 v[68:71], v[124:125], v[194:195], v[68:71]
    s_setprio 1
    v_mfma_f32_4x4x4_16b_bf16 v[72:75], v[124:125], v[196:197], v[72:75]
    v_mfma_f32_4x4x4_16b_bf16 v[60:63], v[108:109], v[176:177], v[60:63]
    v_mfma_f32_4x4x4_16b_bf16 v[64:67], v[108:109], v[178:179], v[64:67]
    v_mfma_f32_4x4x4_16b_bf16 v[68:71], v[126:127], v[196:197], v[68:71]
    v_mfma_f32_4x4x4_16b_bf16 v[72:75], v[126:127], v[198:199], v[72:75]
    s_waitcnt lgkmcnt(15)
    v_mfma_f32_16x16x32_bf16 v[240:243], v[128:131], v[16:19], 0
    ds_read_b64_tr_b16 v[44:45], v85 offset:12288
    v_mfma_f32_16x16x32_bf16 v[240:243], v[136:139], v[20:23], v[240:243]
    ds_read_b64_tr_b16 v[46:47], v85 offset:12544
    ds_read_b128 v[160:163], v76 offset:4096
    v_mfma_f32_16x16x32_bf16 v[244:247], v[132:135], v[16:19], 0
    ds_read_b64_tr_b16 v[48:49], v85 offset:14336
    v_mfma_f32_16x16x32_bf16 v[244:247], v[140:143], v[20:23], v[244:247]
    ds_read_b64_tr_b16 v[50:51], v85 offset:14592
    ds_read_b128 v[164:167], v77 offset:4096
    v_mfma_f32_16x16x32_bf16 v[240:243], v[144:147], v[24:27], v[240:243]
    ds_read_b64_tr_b16 v[16:17], v86
    v_mfma_f32_16x16x32_bf16 v[240:243], v[152:155], v[88:91], v[240:243]
    ds_read_b64_tr_b16 v[18:19], v86 offset:256
    ds_read_b128 v[168:171], v78 offset:4096
    v_mfma_f32_16x16x32_bf16 v[244:247], v[148:151], v[24:27], v[244:247]
    ds_read_b64_tr_b16 v[20:21], v86 offset:2048
    v_mfma_f32_16x16x32_bf16 v[244:247], v[156:159], v[88:91], v[244:247]
    s_waitcnt lgkmcnt(15)
    ds_read_b64_tr_b16 v[22:23], v86 offset:2304
    ds_read_b128 v[172:175], v79 offset:4096
    v_mfma_f32_16x16x32_bf16 v[240:243], v[200:203], v[232:235], v[240:243]
    ds_read_b64_tr_b16 v[24:25], v86 offset:4096
    v_mfma_f32_16x16x32_bf16 v[240:243], v[208:211], v[236:239], v[240:243]
    ds_read_b64_tr_b16 v[26:27], v86 offset:4352
    ds_read_b128 v[176:179], v76 offset:6144
    v_mfma_f32_16x16x32_bf16 v[244:247], v[204:207], v[232:235], v[244:247]
    ds_read_b64_tr_b16 v[88:89], v86 offset:6144
    v_mfma_f32_16x16x32_bf16 v[244:247], v[212:215], v[236:239], v[244:247]
    s_waitcnt lgkmcnt(11)
    ds_read_b64_tr_b16 v[90:91], v86 offset:6400
    ds_read_b128 v[180:183], v76 offset:4352
    v_mfma_f32_16x16x32_bf16 v[240:243], v[216:219], v[44:47], v[240:243]
    ds_read_b64_tr_b16 v[232:233], v86 offset:8192
    v_mfma_f32_16x16x32_bf16 v[240:243], v[224:227], v[48:51], v[240:243]
    ds_read_b64_tr_b16 v[234:235], v86 offset:8448
    ds_read_b128 v[184:187], v77 offset:4352
    v_mfma_f32_16x16x32_bf16 v[244:247], v[220:223], v[44:47], v[244:247]
    ds_read_b64_tr_b16 v[236:237], v86 offset:10240
    v_mfma_f32_16x16x32_bf16 v[244:247], v[228:231], v[48:51], v[244:247]
    s_waitcnt lgkmcnt(11)
    ds_read_b64_tr_b16 v[238:239], v86 offset:10496
    ds_read_b128 v[188:191], v78 offset:4352
    v_mfma_f32_16x16x32_bf16 v[248:251], v[128:131], v[16:19], 0
    ds_read_b64_tr_b16 v[44:45], v86 offset:12288
    v_mfma_f32_16x16x32_bf16 v[248:251], v[136:139], v[20:23], v[248:251]
    ds_read_b64_tr_b16 v[46:47], v86 offset:12544
    ds_read_b128 v[192:195], v79 offset:4352
    v_mfma_f32_16x16x32_bf16 v[252:255], v[132:135], v[16:19], 0
    ds_read_b64_tr_b16 v[48:49], v86 offset:14336
    v_mfma_f32_16x16x32_bf16 v[252:255], v[140:143], v[20:23], v[252:255]
    s_waitcnt lgkmcnt(11)
    ds_read_b64_tr_b16 v[50:51], v86 offset:14592
    ds_read_b128 v[196:199], v76 offset:6400
    v_mfma_f32_16x16x32_bf16 v[248:251], v[144:147], v[24:27], v[248:251]
    v_exp_f32 v0, v60
    v_mfma_f32_16x16x32_bf16 v[248:251], v[152:155], v[88:91], v[248:251]
    v_exp_f32 v15, v61
    v_mfma_f32_16x16x32_bf16 v[252:255], v[148:151], v[24:27], v[252:255]
    v_fmaak_f32 v0, v0, v8, 0xbfb8aa3b
    v_fmaak_f32 v15, v15, v8, 0xbfb8aa3b
    v_mfma_f32_16x16x32_bf16 v[252:255], v[156:159], v[88:91], v[252:255]
    s_waitcnt lgkmcnt(7)
    v_rcp_f32 v0, v0
    v_mfma_f32_16x16x32_bf16 v[248:251], v[200:203], v[232:235], v[248:251]
    v_rcp_f32 v15, v15
    v_mfma_f32_16x16x32_bf16 v[248:251], v[208:211], v[236:239], v[248:251]
    v_mul_f32 v60, v60, v0
    v_mul_f32 v61, v61, v15
    v_mfma_f32_16x16x32_bf16 v[252:255], v[204:207], v[232:235], v[252:255]
    v_exp_f32 v87, v62
    v_mfma_f32_16x16x32_bf16 v[252:255], v[212:215], v[236:239], v[252:255]
    s_waitcnt lgkmcnt(4)
    v_exp_f32 v4, v63
    v_mfma_f32_16x16x32_bf16 v[248:251], v[216:219], v[44:47], v[248:251]
    s_waitcnt lgkmcnt(1)
    v_fmaak_f32 v87, v87, v8, 0xbfb8aa3b
    v_fmaak_f32 v4, v4, v8, 0xbfb8aa3b
    v_mfma_f32_16x16x32_bf16 v[248:251], v[224:227], v[48:51], v[248:251]
    v_rcp_f32 v87, v87
    v_mfma_f32_16x16x32_bf16 v[252:255], v[220:223], v[44:47], v[252:255]
    v_rcp_f32 v4, v4
    v_mfma_f32_16x16x32_bf16 v[252:255], v[228:231], v[48:51], v[252:255]
    s_setprio 0
    v_mul_f32 v62, v62, v87
    v_mul_f32 v63, v63, v4
    v_exp_f32 v0, v64
    v_exp_f32 v15, v65
    v_fmaak_f32 v0, v0, v8, 0xbfb8aa3b
    v_fmaak_f32 v15, v15, v8, 0xbfb8aa3b
    v_rcp_f32 v0, v0
    v_rcp_f32 v15, v15
    v_mul_f32 v64, v64, v0
    v_mul_f32 v65, v65, v15
    v_exp_f32 v87, v66
    v_exp_f32 v4, v67
    v_fmaak_f32 v87, v87, v8, 0xbfb8aa3b
    v_fmaak_f32 v4, v4, v8, 0xbfb8aa3b
    v_rcp_f32 v87, v87
    v_rcp_f32 v4, v4
    v_mul_f32 v66, v66, v87
    v_mul_f32 v67, v67, v4
    v_cvt_pk_bf16_f32 v52, v60, v61
    v_cvt_pk_bf16_f32 v53, v62, v63
    v_cvt_pk_bf16_f32 v54, v64, v65
    v_cvt_pk_bf16_f32 v55, v66, v67
    v_exp_f32 v0, v68
    v_exp_f32 v15, v69
    v_fmaak_f32 v0, v0, v8, 0xbfb8aa3b
    v_fmaak_f32 v15, v15, v8, 0xbfb8aa3b
    v_rcp_f32 v0, v0
    v_rcp_f32 v15, v15
    v_mul_f32 v68, v68, v0
    v_mul_f32 v69, v69, v15
    v_exp_f32 v87, v70
    v_exp_f32 v4, v71
    v_fmaak_f32 v87, v87, v8, 0xbfb8aa3b
    v_fmaak_f32 v4, v4, v8, 0xbfb8aa3b
    v_rcp_f32 v87, v87
    v_rcp_f32 v4, v4
    v_mul_f32 v70, v70, v87
    v_mul_f32 v71, v71, v4
    v_exp_f32 v0, v72
    v_exp_f32 v15, v73
    v_fmaak_f32 v0, v0, v8, 0xbfb8aa3b
    L_pad5:
    s_cbranch_execz L_ret1
    v_fmaak_f32 v15, v15, v8, 0xbfb8aa3b
    v_rcp_f32 v0, v0
    v_rcp_f32 v15, v15
    v_mul_f32 v72, v72, v0
    v_mul_f32 v73, v73, v15
    v_exp_f32 v87, v74
    v_exp_f32 v4, v75
    v_fmaak_f32 v87, v87, v8, 0xbfb8aa3b
    v_fmaak_f32 v4, v4, v8, 0xbfb8aa3b
    v_rcp_f32 v87, v87
    v_rcp_f32 v4, v4
    v_mul_f32 v74, v74, v87
    v_mul_f32 v75, v75, v4
    v_cvt_pk_bf16_f32 v56, v68, v69
    v_cvt_pk_bf16_f32 v57, v70, v71
    v_cvt_pk_bf16_f32 v58, v72, v73
    v_cvt_pk_bf16_f32 v59, v74, v75
    ds_write_b128 v80, v[52:55] offset:16896
    v_cvt_pk_bf16_f32 v28, v240, v241
    v_cvt_pk_bf16_f32 v29, v242, v243
    v_cvt_pk_bf16_f32 v30, v244, v245
    v_cvt_pk_bf16_f32 v31, v246, v247
    v_cvt_pk_bf16_f32 v32, v248, v249
    v_cvt_pk_bf16_f32 v33, v250, v251
    v_cvt_pk_bf16_f32 v34, v252, v253
    v_cvt_pk_bf16_f32 v35, v254, v255
    s_cmp_lt_u32 s33, s32
    s_cbranch_scc0 L_lretb
    v_mov_b32 v12, 0
    v_lshlrev_b32 v15, 4, v10
    v_sub_u32 v15, 8192, v15
    v_add_u32 v0, v15, v6
    ds_write_b32 v0, v12
    ds_write_b32 v0, v12 offset:4
    ds_write_b32 v0, v12 offset:8
    ds_write_b32 v0, v12 offset:12
    ds_write_b32 v0, v12 offset:256
    ds_write_b32 v0, v12 offset:260
    ds_write_b32 v0, v12 offset:264
    ds_write_b32 v0, v12 offset:268
    v_bfe_i32 v87, v11, 5, 1
    v_and_b32 v87, 6144, v87
    v_sub_u32 v76, v76, v87
    v_sub_u32 v77, v77, v87
    v_sub_u32 v78, v78, v87
    v_sub_u32 v79, v79, v87
    s_waitcnt lgkmcnt(0)
    L_lretb:
    v_mfma_f32_4x4x4_16b_bf16 v[60:63], v[92:93], v[160:161], 0
    ds_write_b128 v80, v[56:59] offset:17920
    v_mfma_f32_4x4x4_16b_bf16 v[64:67], v[92:93], v[162:163], 0
    v_mfma_f32_4x4x4_16b_bf16 v[68:71], v[110:111], v[180:181], 0
    v_mfma_f32_4x4x4_16b_bf16 v[72:75], v[110:111], v[182:183], 0
    v_mfma_f32_4x4x4_16b_bf16 v[60:63], v[94:95], v[162:163], v[60:63]
    v_mfma_f32_4x4x4_16b_bf16 v[64:67], v[94:95], v[164:165], v[64:67]
    v_mfma_f32_4x4x4_16b_bf16 v[68:71], v[112:113], v[182:183], v[68:71]
    v_mfma_f32_4x4x4_16b_bf16 v[72:75], v[112:113], v[184:185], v[72:75]
    v_mfma_f32_4x4x4_16b_bf16 v[60:63], v[96:97], v[164:165], v[60:63]
    v_mfma_f32_4x4x4_16b_bf16 v[64:67], v[96:97], v[166:167], v[64:67]
    v_mfma_f32_4x4x4_16b_bf16 v[68:71], v[114:115], v[184:185], v[68:71]
    v_mfma_f32_4x4x4_16b_bf16 v[72:75], v[114:115], v[186:187], v[72:75]
    s_waitcnt lgkmcnt(0)
    s_barrier
    v_mfma_f32_4x4x4_16b_bf16 v[60:63], v[98:99], v[166:167], v[60:63]
    ds_read_b64_tr_b16 v[16:17], v85 offset:16896
    v_mfma_f32_4x4x4_16b_bf16 v[64:67], v[98:99], v[168:169], v[64:67]
    ds_read_b64_tr_b16 v[18:19], v85 offset:17152
    v_mfma_f32_4x4x4_16b_bf16 v[68:71], v[116:117], v[186:187], v[68:71]
    ds_read_b64_tr_b16 v[20:21], v85 offset:18944
    v_mfma_f32_4x4x4_16b_bf16 v[72:75], v[116:117], v[188:189], v[72:75]
    ds_read_b64_tr_b16 v[22:23], v85 offset:19200
    v_mfma_f32_4x4x4_16b_bf16 v[60:63], v[100:101], v[168:169], v[60:63]
    ds_read_b64_tr_b16 v[24:25], v85 offset:20992
    v_mfma_f32_4x4x4_16b_bf16 v[64:67], v[100:101], v[170:171], v[64:67]
    ds_read_b64_tr_b16 v[26:27], v85 offset:21248
    v_mfma_f32_4x4x4_16b_bf16 v[68:71], v[118:119], v[188:189], v[68:71]
    ds_read_b64_tr_b16 v[88:89], v85 offset:23040
    v_mfma_f32_4x4x4_16b_bf16 v[72:75], v[118:119], v[190:191], v[72:75]
    ds_read_b64_tr_b16 v[90:91], v85 offset:23296
    v_mfma_f32_4x4x4_16b_bf16 v[60:63], v[102:103], v[170:171], v[60:63]
    ds_read_b64_tr_b16 v[232:233], v85 offset:25088
    v_mfma_f32_4x4x4_16b_bf16 v[64:67], v[102:103], v[172:173], v[64:67]
    ds_read_b64_tr_b16 v[234:235], v85 offset:25344
    v_mfma_f32_4x4x4_16b_bf16 v[68:71], v[120:121], v[190:191], v[68:71]
    ds_read_b64_tr_b16 v[236:237], v85 offset:27136
    v_mfma_f32_4x4x4_16b_bf16 v[72:75], v[120:121], v[192:193], v[72:75]
    ds_read_b64_tr_b16 v[238:239], v85 offset:27392
    ds_write_b128 v82, v[28:31] offset:50688
    v_mfma_f32_4x4x4_16b_bf16 v[60:63], v[104:105], v[172:173], v[60:63]
    v_mfma_f32_4x4x4_16b_bf16 v[64:67], v[104:105], v[174:175], v[64:67]
    v_mfma_f32_4x4x4_16b_bf16 v[68:71], v[122:123], v[192:193], v[68:71]
    v_mfma_f32_4x4x4_16b_bf16 v[72:75], v[122:123], v[194:195], v[72:75]
    v_mfma_f32_4x4x4_16b_bf16 v[60:63], v[106:107], v[174:175], v[60:63]
    v_mfma_f32_4x4x4_16b_bf16 v[64:67], v[106:107], v[176:177], v[64:67]
    v_mfma_f32_4x4x4_16b_bf16 v[68:71], v[124:125], v[194:195], v[68:71]
    s_setprio 1
    v_mfma_f32_4x4x4_16b_bf16 v[72:75], v[124:125], v[196:197], v[72:75]
    ds_write_b128 v82, v[32:35] offset:51712
    v_mfma_f32_4x4x4_16b_bf16 v[60:63], v[108:109], v[176:177], v[60:63]
    v_mfma_f32_4x4x4_16b_bf16 v[64:67], v[108:109], v[178:179], v[64:67]
    v_mfma_f32_4x4x4_16b_bf16 v[68:71], v[126:127], v[196:197], v[68:71]
    v_mfma_f32_4x4x4_16b_bf16 v[72:75], v[126:127], v[198:199], v[72:75]
    s_waitcnt lgkmcnt(12)
    v_mfma_f32_16x16x32_bf16 v[240:243], v[128:131], v[16:19], 0
    s_waitcnt lgkmcnt(10)
    ds_read_b64_tr_b16 v[44:45], v85 offset:29184
    v_mfma_f32_16x16x32_bf16 v[240:243], v[136:139], v[20:23], v[240:243]
    ds_read_b64_tr_b16 v[46:47], v85 offset:29440
    v_mfma_f32_16x16x32_bf16 v[244:247], v[132:135], v[16:19], 0
    ds_read_b64_tr_b16 v[48:49], v85 offset:31232
    v_mfma_f32_16x16x32_bf16 v[244:247], v[140:143], v[20:23], v[244:247]
    s_waitcnt lgkmcnt(9)
    ds_read_b64_tr_b16 v[50:51], v85 offset:31488
    v_mfma_f32_16x16x32_bf16 v[240:243], v[144:147], v[24:27], v[240:243]
    ds_read_b64_tr_b16 v[16:17], v86 offset:16896
    v_mfma_f32_16x16x32_bf16 v[240:243], v[152:155], v[88:91], v[240:243]
    ds_read_b64_tr_b16 v[18:19], v86 offset:17152
    ds_read_b128 v[36:39], v83 offset:50688
    ds_read_b128 v[40:43], v83 offset:51712
    v_mfma_f32_16x16x32_bf16 v[244:247], v[148:151], v[24:27], v[244:247]
    ds_read_b64_tr_b16 v[20:21], v86 offset:18944
    v_mfma_f32_16x16x32_bf16 v[244:247], v[156:159], v[88:91], v[244:247]
    s_waitcnt lgkmcnt(11)
    ds_read_b64_tr_b16 v[22:23], v86 offset:19200
    v_mfma_f32_16x16x32_bf16 v[240:243], v[200:203], v[232:235], v[240:243]
    ds_read_b64_tr_b16 v[24:25], v86 offset:20992
    v_mfma_f32_16x16x32_bf16 v[240:243], v[208:211], v[236:239], v[240:243]
    ds_read_b64_tr_b16 v[26:27], v86 offset:21248
    v_mfma_f32_16x16x32_bf16 v[244:247], v[204:207], v[232:235], v[244:247]
    ds_read_b64_tr_b16 v[88:89], v86 offset:23040
    v_mfma_f32_16x16x32_bf16 v[244:247], v[212:215], v[236:239], v[244:247]
    s_waitcnt lgkmcnt(9)
    ds_read_b64_tr_b16 v[90:91], v86 offset:23296
    v_mfma_f32_16x16x32_bf16 v[240:243], v[216:219], v[44:47], v[240:243]
    ds_read_b64_tr_b16 v[232:233], v86 offset:25088
    v_mfma_f32_16x16x32_bf16 v[240:243], v[224:227], v[48:51], v[240:243]
    ds_read_b64_tr_b16 v[234:235], v86 offset:25344
    s_add_u32 s53, s52, 8192
    s_waitcnt lgkmcnt(9)
    buffer_store_dwordx4 v[36:39], v5, s[24:27], s53 offen sc0 sc1
    v_mfma_f32_16x16x32_bf16 v[244:247], v[220:223], v[44:47], v[244:247]
    ds_read_b64_tr_b16 v[236:237], v86 offset:27136
    v_mfma_f32_16x16x32_bf16 v[244:247], v[228:231], v[48:51], v[244:247]
    s_waitcnt lgkmcnt(7)
    ds_read_b64_tr_b16 v[238:239], v86 offset:27392
    v_mfma_f32_16x16x32_bf16 v[248:251], v[128:131], v[16:19], 0
    ds_read_b64_tr_b16 v[44:45], v86 offset:29184
    v_mfma_f32_16x16x32_bf16 v[248:251], v[136:139], v[20:23], v[248:251]
    ds_read_b64_tr_b16 v[46:47], v86 offset:29440
    s_add_u32 s53, s52, 16384
    buffer_store_dwordx4 v[40:43], v5, s[24:27], s53 offen sc0 sc1
    v_mfma_f32_16x16x32_bf16 v[252:255], v[132:135], v[16:19], 0
    ds_read_b64_tr_b16 v[48:49], v86 offset:31232
    v_mfma_f32_16x16x32_bf16 v[252:255], v[140:143], v[20:23], v[252:255]
    s_waitcnt lgkmcnt(7)
    ds_read_b64_tr_b16 v[50:51], v86 offset:31488
    s_waitcnt vmcnt(3)
    v_mfma_f32_16x16x32_bf16 v[248:251], v[144:147], v[24:27], v[248:251]
    v_mfma_f32_16x16x32_bf16 v[248:251], v[152:155], v[88:91], v[248:251]
    ds_read_b128 v[160:163], v76 offset:6144
    ds_read_b128 v[164:167], v77 offset:6144
    v_mfma_f32_16x16x32_bf16 v[252:255], v[148:151], v[24:27], v[252:255]
    v_mfma_f32_16x16x32_bf16 v[252:255], v[156:159], v[88:91], v[252:255]
    s_waitcnt lgkmcnt(6)
    ds_read_b128 v[168:171], v78 offset:6144
    ds_read_b128 v[172:175], v79 offset:6144
    v_mfma_f32_16x16x32_bf16 v[248:251], v[200:203], v[232:235], v[248:251]
    v_mfma_f32_16x16x32_bf16 v[248:251], v[208:211], v[236:239], v[248:251]
    ds_read_b128 v[176:179], v76 offset:8192
    ds_read_b128 v[180:183], v76 offset:6400
    v_mfma_f32_16x16x32_bf16 v[252:255], v[204:207], v[232:235], v[252:255]
    v_mfma_f32_16x16x32_bf16 v[252:255], v[212:215], v[236:239], v[252:255]
    s_waitcnt lgkmcnt(8)
    ds_read_b128 v[184:187], v77 offset:6400
    ds_read_b128 v[188:191], v78 offset:6400
    v_mfma_f32_16x16x32_bf16 v[248:251], v[216:219], v[44:47], v[248:251]
    s_waitcnt lgkmcnt(8)
    v_mfma_f32_16x16x32_bf16 v[248:251], v[224:227], v[48:51], v[248:251]
    ds_read_b128 v[192:195], v79 offset:6400
    ds_read_b128 v[196:199], v76 offset:8448
    v_mfma_f32_16x16x32_bf16 v[252:255], v[220:223], v[44:47], v[252:255]
    v_mfma_f32_16x16x32_bf16 v[252:255], v[228:231], v[48:51], v[252:255]
    s_setprio 0
    v_exp_f32 v0, v60
    v_exp_f32 v15, v61
    v_fmaak_f32 v0, v0, v8, 0xbfb8aa3b
    v_fmaak_f32 v15, v15, v8, 0xbfb8aa3b
    v_rcp_f32 v0, v0
    v_rcp_f32 v15, v15
    v_mul_f32 v60, v60, v0
    v_mul_f32 v61, v61, v15
    v_exp_f32 v87, v62
    v_exp_f32 v4, v63
    v_fmaak_f32 v87, v87, v8, 0xbfb8aa3b
    v_fmaak_f32 v4, v4, v8, 0xbfb8aa3b
    v_cvt_pk_bf16_f32 v28, v240, v241
    v_cvt_pk_bf16_f32 v29, v242, v243
    v_cvt_pk_bf16_f32 v30, v244, v245
    v_cvt_pk_bf16_f32 v31, v246, v247
    v_cvt_pk_bf16_f32 v32, v248, v249
    v_cvt_pk_bf16_f32 v33, v250, v251
    v_cvt_pk_bf16_f32 v34, v252, v253
    v_cvt_pk_bf16_f32 v35, v254, v255
    v_rcp_f32 v87, v87
    v_rcp_f32 v4, v4
    v_mul_f32 v62, v62, v87
    v_mul_f32 v63, v63, v4
    v_exp_f32 v0, v64
    v_exp_f32 v15, v65
    v_fmaak_f32 v0, v0, v8, 0xbfb8aa3b
    v_fmaak_f32 v15, v15, v8, 0xbfb8aa3b
    v_rcp_f32 v0, v0
    v_rcp_f32 v15, v15
    v_mul_f32 v64, v64, v0
    v_mul_f32 v65, v65, v15
    v_exp_f32 v87, v66
    v_exp_f32 v4, v67
    v_fmaak_f32 v87, v87, v8, 0xbfb8aa3b
    v_fmaak_f32 v4, v4, v8, 0xbfb8aa3b
    v_rcp_f32 v87, v87
    v_rcp_f32 v4, v4
    v_mul_f32 v66, v66, v87
    v_mul_f32 v67, v67, v4
    v_cvt_pk_bf16_f32 v52, v60, v61
    v_cvt_pk_bf16_f32 v53, v62, v63
    v_cvt_pk_bf16_f32 v54, v64, v65
    v_cvt_pk_bf16_f32 v55, v66, v67
    v_exp_f32 v0, v68
    v_exp_f32 v15, v69
    v_fmaak_f32 v0, v0, v8, 0xbfb8aa3b
    v_fmaak_f32 v15, v15, v8, 0xbfb8aa3b
    v_rcp_f32 v0, v0
    v_rcp_f32 v15, v15
    v_mul_f32 v68, v68, v0
    v_mul_f32 v69, v69, v15
    v_exp_f32 v87, v70
    v_exp_f32 v4, v71
    v_fmaak_f32 v87, v87, v8, 0xbfb8aa3b
    v_fmaak_f32 v4, v4, v8, 0xbfb8aa3b
    v_rcp_f32 v87, v87
    v_rcp_f32 v4, v4
    v_mul_f32 v70, v70, v87
    v_mul_f32 v71, v71, v4
    v_exp_f32 v0, v72
    v_exp_f32 v15, v73
    v_fmaak_f32 v0, v0, v8, 0xbfb8aa3b
    v_fmaak_f32 v15, v15, v8, 0xbfb8aa3b
    v_rcp_f32 v0, v0
    v_rcp_f32 v15, v15
    v_mul_f32 v72, v72, v0
    v_mul_f32 v73, v73, v15
    v_exp_f32 v87, v74
    v_exp_f32 v4, v75
    v_fmaak_f32 v87, v87, v8, 0xbfb8aa3b
    v_fmaak_f32 v4, v4, v8, 0xbfb8aa3b
    v_rcp_f32 v87, v87
    v_rcp_f32 v4, v4
    v_mul_f32 v74, v74, v87
    v_mul_f32 v75, v75, v4
    v_cvt_pk_bf16_f32 v56, v68, v69
    v_cvt_pk_bf16_f32 v57, v70, v71
    ds_write_b128 v80, v[52:55]
    v_cvt_pk_bf16_f32 v58, v72, v73
    v_cvt_pk_bf16_f32 v59, v74, v75
    s_waitcnt lgkmcnt(10)
    v_mfma_f32_4x4x4_16b_bf16 v[60:63], v[92:93], v[160:161], 0
    ds_write_b128 v80, v[56:59] offset:1024
    v_mfma_f32_4x4x4_16b_bf16 v[64:67], v[92:93], v[162:163], 0
    s_waitcnt lgkmcnt(6)
    v_mfma_f32_4x4x4_16b_bf16 v[68:71], v[110:111], v[180:181], 0
    v_mfma_f32_4x4x4_16b_bf16 v[72:75], v[110:111], v[182:183], 0
    v_mfma_f32_4x4x4_16b_bf16 v[60:63], v[94:95], v[162:163], v[60:63]
    v_mfma_f32_4x4x4_16b_bf16 v[64:67], v[94:95], v[164:165], v[64:67]
    v_mfma_f32_4x4x4_16b_bf16 v[68:71], v[112:113], v[182:183], v[68:71]
    s_waitcnt lgkmcnt(5)
    v_mfma_f32_4x4x4_16b_bf16 v[72:75], v[112:113], v[184:185], v[72:75]
    v_mfma_f32_4x4x4_16b_bf16 v[60:63], v[96:97], v[164:165], v[60:63]
    v_mfma_f32_4x4x4_16b_bf16 v[64:67], v[96:97], v[166:167], v[64:67]
    v_mfma_f32_4x4x4_16b_bf16 v[68:71], v[114:115], v[184:185], v[68:71]
    v_mfma_f32_4x4x4_16b_bf16 v[72:75], v[114:115], v[186:187], v[72:75]
    s_waitcnt lgkmcnt(0)
    s_barrier
    v_mfma_f32_4x4x4_16b_bf16 v[60:63], v[98:99], v[166:167], v[60:63]
    ds_read_b64_tr_b16 v[16:17], v85
    v_mfma_f32_4x4x4_16b_bf16 v[64:67], v[98:99], v[168:169], v[64:67]
    ds_read_b64_tr_b16 v[18:19], v85 offset:256
    v_mfma_f32_4x4x4_16b_bf16 v[68:71], v[116:117], v[186:187], v[68:71]
    ds_read_b64_tr_b16 v[20:21], v85 offset:2048
    v_mfma_f32_4x4x4_16b_bf16 v[72:75], v[116:117], v[188:189], v[72:75]
    ds_read_b64_tr_b16 v[22:23], v85 offset:2304
    v_mfma_f32_4x4x4_16b_bf16 v[60:63], v[100:101], v[168:169], v[60:63]
    ds_read_b64_tr_b16 v[24:25], v85 offset:4096
    v_mfma_f32_4x4x4_16b_bf16 v[64:67], v[100:101], v[170:171], v[64:67]
    ds_read_b64_tr_b16 v[26:27], v85 offset:4352
    v_mfma_f32_4x4x4_16b_bf16 v[68:71], v[118:119], v[188:189], v[68:71]
    ds_read_b64_tr_b16 v[88:89], v85 offset:6144
    v_mfma_f32_4x4x4_16b_bf16 v[72:75], v[118:119], v[190:191], v[72:75]
    ds_read_b64_tr_b16 v[90:91], v85 offset:6400
    v_mfma_f32_4x4x4_16b_bf16 v[60:63], v[102:103], v[170:171], v[60:63]
    ds_read_b64_tr_b16 v[232:233], v85 offset:8192
    v_mfma_f32_4x4x4_16b_bf16 v[64:67], v[102:103], v[172:173], v[64:67]
    ds_read_b64_tr_b16 v[234:235], v85 offset:8448
    v_mfma_f32_4x4x4_16b_bf16 v[68:71], v[120:121], v[190:191], v[68:71]
    ds_read_b64_tr_b16 v[236:237], v85 offset:10240
    v_mfma_f32_4x4x4_16b_bf16 v[72:75], v[120:121], v[192:193], v[72:75]
    ds_read_b64_tr_b16 v[238:239], v85 offset:10496
    ds_write_b128 v82, v[28:31] offset:50688
    v_mfma_f32_4x4x4_16b_bf16 v[60:63], v[104:105], v[172:173], v[60:63]
    v_mfma_f32_4x4x4_16b_bf16 v[64:67], v[104:105], v[174:175], v[64:67]
    v_mfma_f32_4x4x4_16b_bf16 v[68:71], v[122:123], v[192:193], v[68:71]
    v_mfma_f32_4x4x4_16b_bf16 v[72:75], v[122:123], v[194:195], v[72:75]
    v_mfma_f32_4x4x4_16b_bf16 v[60:63], v[106:107], v[174:175], v[60:63]
    v_mfma_f32_4x4x4_16b_bf16 v[64:67], v[106:107], v[176:177], v[64:67]
    v_mfma_f32_4x4x4_16b_bf16 v[68:71], v[124:125], v[194:195], v[68:71]
    s_setprio 1
    v_mfma_f32_4x4x4_16b_bf16 v[72:75], v[124:125], v[196:197], v[72:75]
    ds_write_b128 v82, v[32:35] offset:51712
    v_mfma_f32_4x4x4_16b_bf16 v[60:63], v[108:109], v[176:177], v[60:63]
    v_mfma_f32_4x4x4_16b_bf16 v[64:67], v[108:109], v[178:179], v[64:67]
    v_mfma_f32_4x4x4_16b_bf16 v[68:71], v[126:127], v[196:197], v[68:71]
    v_mfma_f32_4x4x4_16b_bf16 v[72:75], v[126:127], v[198:199], v[72:75]
    s_waitcnt lgkmcnt(12)
    v_mfma_f32_16x16x32_bf16 v[240:243], v[128:131], v[16:19], 0
    s_waitcnt lgkmcnt(10)
    ds_read_b64_tr_b16 v[44:45], v85 offset:12288
    v_mfma_f32_16x16x32_bf16 v[240:243], v[136:139], v[20:23], v[240:243]
    ds_read_b64_tr_b16 v[46:47], v85 offset:12544
    v_mfma_f32_16x16x32_bf16 v[244:247], v[132:135], v[16:19], 0
    ds_read_b64_tr_b16 v[48:49], v85 offset:14336
    v_mfma_f32_16x16x32_bf16 v[244:247], v[140:143], v[20:23], v[244:247]
    s_waitcnt lgkmcnt(9)
    ds_read_b64_tr_b16 v[50:51], v85 offset:14592
    v_mfma_f32_16x16x32_bf16 v[240:243], v[144:147], v[24:27], v[240:243]
    ds_read_b64_tr_b16 v[16:17], v86
    v_mfma_f32_16x16x32_bf16 v[240:243], v[152:155], v[88:91], v[240:243]
    ds_read_b64_tr_b16 v[18:19], v86 offset:256
    ds_read_b128 v[36:39], v83 offset:50688
    ds_read_b128 v[40:43], v83 offset:51712
    v_mfma_f32_16x16x32_bf16 v[244:247], v[148:151], v[24:27], v[244:247]
    ds_read_b64_tr_b16 v[20:21], v86 offset:2048
    v_mfma_f32_16x16x32_bf16 v[244:247], v[156:159], v[88:91], v[244:247]
    s_waitcnt lgkmcnt(11)
    ds_read_b64_tr_b16 v[22:23], v86 offset:2304
    v_mfma_f32_16x16x32_bf16 v[240:243], v[200:203], v[232:235], v[240:243]
    ds_read_b64_tr_b16 v[24:25], v86 offset:4096
    v_mfma_f32_16x16x32_bf16 v[240:243], v[208:211], v[236:239], v[240:243]
    ds_read_b64_tr_b16 v[26:27], v86 offset:4352
    v_mfma_f32_16x16x32_bf16 v[244:247], v[204:207], v[232:235], v[244:247]
    ds_read_b64_tr_b16 v[88:89], v86 offset:6144
    v_mfma_f32_16x16x32_bf16 v[244:247], v[212:215], v[236:239], v[244:247]
    s_waitcnt lgkmcnt(9)
    ds_read_b64_tr_b16 v[90:91], v86 offset:6400
    v_mfma_f32_16x16x32_bf16 v[240:243], v[216:219], v[44:47], v[240:243]
    ds_read_b64_tr_b16 v[232:233], v86 offset:8192
    v_mfma_f32_16x16x32_bf16 v[240:243], v[224:227], v[48:51], v[240:243]
    ds_read_b64_tr_b16 v[234:235], v86 offset:8448
    s_add_u32 s53, s52, 24576
    s_waitcnt lgkmcnt(9)
    buffer_store_dwordx4 v[36:39], v5, s[24:27], s53 offen sc0 sc1
    v_mfma_f32_16x16x32_bf16 v[244:247], v[220:223], v[44:47], v[244:247]
    ds_read_b64_tr_b16 v[236:237], v86 offset:10240
    v_mfma_f32_16x16x32_bf16 v[244:247], v[228:231], v[48:51], v[244:247]
    s_waitcnt lgkmcnt(7)
    ds_read_b64_tr_b16 v[238:239], v86 offset:10496
    v_mfma_f32_16x16x32_bf16 v[248:251], v[128:131], v[16:19], 0
    ds_read_b64_tr_b16 v[44:45], v86 offset:12288
    v_mfma_f32_16x16x32_bf16 v[248:251], v[136:139], v[20:23], v[248:251]
    ds_read_b64_tr_b16 v[46:47], v86 offset:12544
    s_add_u32 s53, s52, 32768
    buffer_store_dwordx4 v[40:43], v5, s[24:27], s53 offen sc0 sc1
    v_mfma_f32_16x16x32_bf16 v[252:255], v[132:135], v[16:19], 0
    ds_read_b64_tr_b16 v[48:49], v86 offset:14336
    v_mfma_f32_16x16x32_bf16 v[252:255], v[140:143], v[20:23], v[252:255]
    s_waitcnt lgkmcnt(7)
    ds_read_b64_tr_b16 v[50:51], v86 offset:14592
    v_mfma_f32_16x16x32_bf16 v[248:251], v[144:147], v[24:27], v[248:251]
    v_mfma_f32_16x16x32_bf16 v[248:251], v[152:155], v[88:91], v[248:251]
    v_mfma_f32_16x16x32_bf16 v[252:255], v[148:151], v[24:27], v[252:255]
    v_mfma_f32_16x16x32_bf16 v[252:255], v[156:159], v[88:91], v[252:255]
    s_waitcnt lgkmcnt(4)
    v_mfma_f32_16x16x32_bf16 v[248:251], v[200:203], v[232:235], v[248:251]
    v_mfma_f32_16x16x32_bf16 v[248:251], v[208:211], v[236:239], v[248:251]
    v_mfma_f32_16x16x32_bf16 v[252:255], v[204:207], v[232:235], v[252:255]
    v_mfma_f32_16x16x32_bf16 v[252:255], v[212:215], v[236:239], v[252:255]
    s_waitcnt lgkmcnt(2)
    v_mfma_f32_16x16x32_bf16 v[248:251], v[216:219], v[44:47], v[248:251]
    s_waitcnt lgkmcnt(0)
    v_mfma_f32_16x16x32_bf16 v[248:251], v[224:227], v[48:51], v[248:251]
    v_mfma_f32_16x16x32_bf16 v[252:255], v[220:223], v[44:47], v[252:255]
    v_mfma_f32_16x16x32_bf16 v[252:255], v[228:231], v[48:51], v[252:255]
    s_setprio 3
    v_exp_f32 v0, v60
    v_exp_f32 v15, v61
    v_fmaak_f32 v0, v0, v8, 0xbfb8aa3b
    v_fmaak_f32 v15, v15, v8, 0xbfb8aa3b
    v_rcp_f32 v0, v0
    v_rcp_f32 v15, v15
    v_mul_f32 v60, v60, v0
    v_mul_f32 v61, v61, v15
    v_exp_f32 v87, v62
    v_exp_f32 v4, v63
    v_fmaak_f32 v87, v87, v8, 0xbfb8aa3b
    v_fmaak_f32 v4, v4, v8, 0xbfb8aa3b
    v_cvt_pk_bf16_f32 v28, v240, v241
    v_cvt_pk_bf16_f32 v29, v242, v243
    v_cvt_pk_bf16_f32 v30, v244, v245
    v_cvt_pk_bf16_f32 v31, v246, v247
    v_cvt_pk_bf16_f32 v32, v248, v249
    v_cvt_pk_bf16_f32 v33, v250, v251
    v_cvt_pk_bf16_f32 v34, v252, v253
    v_cvt_pk_bf16_f32 v35, v254, v255
    v_rcp_f32 v87, v87
    v_rcp_f32 v4, v4
    ds_write_b128 v82, v[28:31] offset:50688
    v_mul_f32 v62, v62, v87
    v_mul_f32 v63, v63, v4
    v_exp_f32 v0, v64
    v_exp_f32 v15, v65
    v_fmaak_f32 v0, v0, v8, 0xbfb8aa3b
    v_fmaak_f32 v15, v15, v8, 0xbfb8aa3b
    v_rcp_f32 v0, v0
    v_rcp_f32 v15, v15
    v_mul_f32 v64, v64, v0
    v_mul_f32 v65, v65, v15
    v_exp_f32 v87, v66
    ds_write_b128 v82, v[32:35] offset:51712
    v_exp_f32 v4, v67
    v_fmaak_f32 v87, v87, v8, 0xbfb8aa3b
    v_fmaak_f32 v4, v4, v8, 0xbfb8aa3b
    v_rcp_f32 v87, v87
    v_rcp_f32 v4, v4
    v_mul_f32 v66, v66, v87
    v_mul_f32 v67, v67, v4
    v_cvt_pk_bf16_f32 v60, v60, v61
    v_cvt_pk_bf16_f32 v61, v62, v63
    v_cvt_pk_bf16_f32 v62, v64, v65
    v_cvt_pk_bf16_f32 v63, v66, v67
    ds_read_b128 v[36:39], v83 offset:50688
    ds_read_b128 v[40:43], v83 offset:51712
    v_exp_f32 v0, v68
    v_exp_f32 v15, v69
    v_fmaak_f32 v0, v0, v8, 0xbfb8aa3b
    v_fmaak_f32 v15, v15, v8, 0xbfb8aa3b
    v_rcp_f32 v0, v0
    v_rcp_f32 v15, v15
    v_mul_f32 v68, v68, v0
    v_mul_f32 v69, v69, v15
    v_exp_f32 v87, v70
    v_exp_f32 v4, v71
    v_fmaak_f32 v87, v87, v8, 0xbfb8aa3b
    s_add_u32 s53, s52, 40960
    s_waitcnt lgkmcnt(1)
    buffer_store_dwordx4 v[36:39], v5, s[24:27], s53 offen sc0 sc1
    v_fmaak_f32 v4, v4, v8, 0xbfb8aa3b
    v_rcp_f32 v87, v87
    v_rcp_f32 v4, v4
    v_mul_f32 v70, v70, v87
    v_mul_f32 v71, v71, v4
    v_exp_f32 v0, v72
    v_exp_f32 v15, v73
    v_fmaak_f32 v0, v0, v8, 0xbfb8aa3b
    v_fmaak_f32 v15, v15, v8, 0xbfb8aa3b
    v_rcp_f32 v0, v0
    v_rcp_f32 v15, v15
    s_add_u32 s53, s52, 49152
    s_waitcnt lgkmcnt(0)
    buffer_store_dwordx4 v[40:43], v5, s[24:27], s53 offen sc0 sc1
    v_mul_f32 v72, v72, v0
    v_mul_f32 v73, v73, v15
    v_exp_f32 v87, v74
    v_exp_f32 v4, v75
    v_fmaak_f32 v87, v87, v8, 0xbfb8aa3b
    v_fmaak_f32 v4, v4, v8, 0xbfb8aa3b
    v_rcp_f32 v87, v87
    v_rcp_f32 v4, v4
    v_mul_f32 v74, v74, v87
    v_mul_f32 v75, v75, v4
    v_cvt_pk_bf16_f32 v68, v68, v69
    v_cvt_pk_bf16_f32 v69, v70, v71
    v_cvt_pk_bf16_f32 v70, v72, v73
    v_cvt_pk_bf16_f32 v71, v74, v75
    ds_write_b128 v80, v[60:63] offset:16896
    ds_write_b128 v80, v[68:71] offset:17920
    s_waitcnt lgkmcnt(0)
    s_barrier
    s_setprio  0
    ds_read_b64_tr_b16 v[16:17], v85 offset:16896
    ds_read_b64_tr_b16 v[18:19], v85 offset:17152
    ds_read_b64_tr_b16 v[20:21], v85 offset:18944
    ds_read_b64_tr_b16 v[22:23], v85 offset:19200
    ds_read_b64_tr_b16 v[24:25], v85 offset:20992
    ds_read_b64_tr_b16 v[26:27], v85 offset:21248
    ds_read_b64_tr_b16 v[88:89], v85 offset:23040
    ds_read_b64_tr_b16 v[90:91], v85 offset:23296
    ds_read_b64_tr_b16 v[232:233], v85 offset:25088
    ds_read_b64_tr_b16 v[234:235], v85 offset:25344
    ds_read_b64_tr_b16 v[236:237], v85 offset:27136
    ds_read_b64_tr_b16 v[238:239], v85 offset:27392
    ds_read_b64_tr_b16 v[44:45], v85 offset:29184
    ds_read_b64_tr_b16 v[46:47], v85 offset:29440
    s_waitcnt lgkmcnt(12)
    v_mfma_f32_16x16x32_bf16 v[240:243], v[128:131], v[16:19], 0
    s_waitcnt lgkmcnt(10)
    ds_read_b64_tr_b16 v[48:49], v85 offset:31232
    v_mfma_f32_16x16x32_bf16 v[240:243], v[136:139], v[20:23], v[240:243]
    ds_read_b64_tr_b16 v[50:51], v85 offset:31488
    v_mfma_f32_16x16x32_bf16 v[244:247], v[132:135], v[16:19], 0
    v_mfma_f32_16x16x32_bf16 v[244:247], v[140:143], v[20:23], v[244:247]
    s_waitcnt lgkmcnt(8)
    ds_read_b64_tr_b16 v[16:17], v86 offset:16896
    v_mfma_f32_16x16x32_bf16 v[240:243], v[144:147], v[24:27], v[240:243]
    ds_read_b64_tr_b16 v[18:19], v86 offset:17152
    v_mfma_f32_16x16x32_bf16 v[240:243], v[152:155], v[88:91], v[240:243]
    ds_read_b64_tr_b16 v[20:21], v86 offset:18944
    v_mfma_f32_16x16x32_bf16 v[244:247], v[148:151], v[24:27], v[244:247]
    ds_read_b64_tr_b16 v[22:23], v86 offset:19200
    v_mfma_f32_16x16x32_bf16 v[244:247], v[156:159], v[88:91], v[244:247]
    s_waitcnt lgkmcnt(8)
    ds_read_b64_tr_b16 v[24:25], v86 offset:20992
    v_mfma_f32_16x16x32_bf16 v[240:243], v[200:203], v[232:235], v[240:243]
    ds_read_b64_tr_b16 v[26:27], v86 offset:21248
    v_mfma_f32_16x16x32_bf16 v[240:243], v[208:211], v[236:239], v[240:243]
    ds_read_b64_tr_b16 v[88:89], v86 offset:23040
    v_mfma_f32_16x16x32_bf16 v[244:247], v[204:207], v[232:235], v[244:247]
    ds_read_b64_tr_b16 v[90:91], v86 offset:23296
    v_mfma_f32_16x16x32_bf16 v[244:247], v[212:215], v[236:239], v[244:247]
    s_waitcnt lgkmcnt(8)
    ds_read_b64_tr_b16 v[232:233], v86 offset:25088
    v_mfma_f32_16x16x32_bf16 v[240:243], v[216:219], v[44:47], v[240:243]
    ds_read_b64_tr_b16 v[234:235], v86 offset:25344
    v_mfma_f32_16x16x32_bf16 v[240:243], v[224:227], v[48:51], v[240:243]
    ds_read_b64_tr_b16 v[236:237], v86 offset:27136
    v_mfma_f32_16x16x32_bf16 v[244:247], v[220:223], v[44:47], v[244:247]
    ds_read_b64_tr_b16 v[238:239], v86 offset:27392
    v_mfma_f32_16x16x32_bf16 v[244:247], v[228:231], v[48:51], v[244:247]
    s_waitcnt lgkmcnt(8)
    ds_read_b64_tr_b16 v[44:45], v86 offset:29184
    v_mfma_f32_16x16x32_bf16 v[248:251], v[128:131], v[16:19], 0
    ds_read_b64_tr_b16 v[46:47], v86 offset:29440
    v_mfma_f32_16x16x32_bf16 v[248:251], v[136:139], v[20:23], v[248:251]
    ds_read_b64_tr_b16 v[48:49], v86 offset:31232
    v_mfma_f32_16x16x32_bf16 v[252:255], v[132:135], v[16:19], 0
    ds_read_b64_tr_b16 v[50:51], v86 offset:31488
    v_mfma_f32_16x16x32_bf16 v[252:255], v[140:143], v[20:23], v[252:255]
    s_waitcnt lgkmcnt(8)
    v_mfma_f32_16x16x32_bf16 v[248:251], v[144:147], v[24:27], v[248:251]
    v_mfma_f32_16x16x32_bf16 v[248:251], v[152:155], v[88:91], v[248:251]
    v_mfma_f32_16x16x32_bf16 v[252:255], v[148:151], v[24:27], v[252:255]
    v_mfma_f32_16x16x32_bf16 v[252:255], v[156:159], v[88:91], v[252:255]
    s_waitcnt lgkmcnt(4)
    v_cvt_pk_bf16_f32 v28, v240, v241
    v_cvt_pk_bf16_f32 v29, v242, v243
    v_mfma_f32_16x16x32_bf16 v[248:251], v[200:203], v[232:235], v[248:251]
    v_mfma_f32_16x16x32_bf16 v[248:251], v[208:211], v[236:239], v[248:251]
    v_cvt_pk_bf16_f32 v30, v244, v245
    v_cvt_pk_bf16_f32 v31, v246, v247
    v_mfma_f32_16x16x32_bf16 v[252:255], v[204:207], v[232:235], v[252:255]
    v_mfma_f32_16x16x32_bf16 v[252:255], v[212:215], v[236:239], v[252:255]
    s_waitcnt lgkmcnt(2)
    ds_write_b128 v82, v[28:31] offset:50688
    v_mfma_f32_16x16x32_bf16 v[248:251], v[216:219], v[44:47], v[248:251]
    s_waitcnt lgkmcnt(1)
    v_mfma_f32_16x16x32_bf16 v[248:251], v[224:227], v[48:51], v[248:251]
    v_mfma_f32_16x16x32_bf16 v[252:255], v[220:223], v[44:47], v[252:255]
    s_setprio 1
    v_mfma_f32_16x16x32_bf16 v[252:255], v[228:231], v[48:51], v[252:255]
    s_setprio 3
    ds_read_b128 v[36:39], v83 offset:50688
    s_add_u32 s53, s52, 57344
    s_waitcnt lgkmcnt(0)
    buffer_store_dwordx4 v[36:39], v5, s[24:27], s53 offen sc0 sc1
    v_cvt_pk_bf16_f32 v32, v248, v249
    v_cvt_pk_bf16_f32 v33, v250, v251
    s_nop 0
    v_cvt_pk_bf16_f32 v34, v252, v253
    v_cvt_pk_bf16_f32 v35, v254, v255
    ds_write_b128 v82, v[32:35] offset:51712
    ds_read_b128 v[40:43], v83 offset:51712
    s_waitcnt lgkmcnt(0)
    buffer_store_dwordx4 v[40:43], v5, s[24:27], s63 offen sc0 sc1
    L_tail:
L_end:
    s_endpgm
.section .rodata,"a"
.p2align 6
.amdhsa_kernel standalone__conformer_conv_module__speech_kernel
  .amdhsa_next_free_vgpr 256
  .amdhsa_next_free_sgpr 102
  .amdhsa_accum_offset 256
  .amdhsa_group_segment_fixed_size 0
  .amdhsa_kernarg_size 56
  .amdhsa_user_sgpr_count 2
  .amdhsa_user_sgpr_kernarg_segment_ptr 1
  .amdhsa_system_sgpr_workgroup_id_x 1
.end_amdhsa_kernel
```
